```python
import torch

def _softmax(x, axis=-1):
    return torch.softmax(x, dim=axis)
def _gelu(x):
    return torch.nn.functional.gelu(x, approximate="tanh")
def _silu(x):
    return torch.nn.functional.silu(x)
def _sigmoid(x):
    return torch.sigmoid(x)
def _layernorm(x, axis=-1, eps=1e-5):
    m = x.mean(dim=axis, keepdim=True)
    v = x.var(dim=axis, keepdim=True, unbiased=False)
    return (x - m) / torch.sqrt(v + eps)
def _scatter_add(tgt, idx, src, axis=0):
    return tgt.clone().index_add_(axis, idx, src)
def _segment_sum(src, seg, n):
    out = torch.zeros((n,) + src.shape[1:], dtype=src.dtype)
    return out.index_add_(0, seg, src)
def _pad(x, pw):
    flat = tuple(v for pair in reversed(pw) for v in pair)
    return torch.nn.functional.pad(x, flat)

kernel_name = 'concat_heads__mha_block_cached__gqa_block_cached__near_ridge'

def setup_inputs():

    _w = (lambda a: (lambda t: t.to(torch.bfloat16) if t.is_floating_point() else t)(torch.as_tensor(a)))
    def _A_setup():
        B, Sq, D = 16, 96, 1024
        H, Sk, Dh = 32, 512, 128
        return {
            "x": _w((lambda *s: torch.randn(*s, dtype=torch.bfloat16) * 0.8)(B, Sq, D)),
            "k_cache": _w((lambda *s: torch.randn(*s, dtype=torch.bfloat16) * 0.8)(B, H, Sk, Dh)),
            "v_cache": _w((lambda *s: torch.randn(*s, dtype=torch.bfloat16) * 0.05)(B, H, Sk, Dh)),
            "wq": _w((lambda *s: torch.randn(*s, dtype=torch.bfloat16) * 0.8)(D, H * Dh) * (D ** -0.5)),
            "wo": _w((lambda *s: torch.randn(*s, dtype=torch.bfloat16) * 0.05)(H * Dh, D) * ((H * Dh) ** -0.5)),
        }
    _A_in = _A_setup()

    def _B_setup():
        B, Sq, D = 16, 96, 1024
        Hq, Hkv, Sk, Dh = 32, 32, 512, 128
        assert Hq % Hkv == 0, (Hq, Hkv)
        return {
            "x": _w((lambda *s: torch.randn(*s, dtype=torch.bfloat16) * 0.8)(B, Sq, D)),
            "k_cache": _w((lambda *s: torch.randn(*s, dtype=torch.bfloat16) * 0.8)(B, Hkv, Sk, Dh)),
            "v_cache": _w((lambda *s: torch.randn(*s, dtype=torch.bfloat16) * 0.05)(B, Hkv, Sk, Dh)),
            "wq": _w((lambda *s: torch.randn(*s, dtype=torch.bfloat16) * 0.8)(D, Hq * Dh) * (D ** -0.5)),
            "wo": _w((lambda *s: torch.randn(*s, dtype=torch.bfloat16) * 0.05)(Hq * Dh, D) * ((Hq * Dh) ** -0.5)),
        }
    _B_in = _B_setup()

    return {
        "A_x": _A_in["x"],
        "A_k_cache": _A_in["k_cache"],
        "A_v_cache": _A_in["v_cache"],
        "A_wq": _A_in["wq"],
        "A_wo": _A_in["wo"],
        "B_x": _B_in["x"],
        "B_k_cache": _B_in["k_cache"],
        "B_v_cache": _B_in["v_cache"],
        "B_wq": _B_in["wq"],
        "B_wo": _B_in["wo"],
    }

def reference(A_x, A_k_cache, A_v_cache, A_wq, A_wo, B_x, B_k_cache, B_v_cache, B_wq, B_wo):
    def _A_ref(x, k_cache, v_cache, wq, wo):
        B, Sq, D = x.shape
        H, Dh = 32, 128
        q = (lambda x, *d: x.permute(*d))((x @ wq).reshape(B, Sq, H, Dh), 0, 2, 1, 3)
        scores = torch.einsum("bhqd,bhkd->bhqk", q, k_cache) * (Dh ** -0.5)
        p = _softmax(scores, axis=-1)
        o = torch.einsum("bhqk,bhkd->bhqd", p, v_cache)
        return (lambda x, *d: x.permute(*d))(o, 0, 2, 1, 3).reshape(B, Sq, H * Dh) @ wo

    def _B_ref(x, k_cache, v_cache, wq, wo):
        B, Sq, D = x.shape
        Hq, Dh = 32, 128
        Hkv = k_cache.shape[1]
        rep = Hq // Hkv
        q = (lambda x, *d: x.permute(*d))((x @ wq).reshape(B, Sq, Hq, Dh), 0, 2, 1, 3)
        k = (lambda x, n, axis: torch.repeat_interleave(x, n, dim=axis))(k_cache, rep, axis=1)
        v = (lambda x, n, axis: torch.repeat_interleave(x, n, dim=axis))(v_cache, rep, axis=1)
        scores = torch.einsum("bhqd,bhkd->bhqk", q, k) * (Dh ** -0.5)
        p = _softmax(scores, axis=-1)
        o = torch.einsum("bhqk,bhkd->bhqd", p, v)
        return (lambda x, *d: x.permute(*d))(o, 0, 2, 1, 3).reshape(B, Sq, Hq * Dh) @ wo

    a = _A_ref(A_x, A_k_cache, A_v_cache, A_wq, A_wo)
    b = _B_ref(B_x, B_k_cache, B_v_cache, B_wq, B_wo)
    return torch.concatenate([a, b], axis=-1)
```

```asm
; @launch grid=(256,1,1) block=(512,1,1) lds=163840
.amdgcn_target "amdgcn-amd-amdhsa--gfx950"
.text
.globl concat_heads__mha_block_cached__gqa_block_cached__near_ridge_kernel
.p2align 8
.type concat_heads__mha_block_cached__gqa_block_cached__near_ridge_kernel,@function
concat_heads__mha_block_cached__gqa_block_cached__near_ridge_kernel:
    s_cmp_ge_u32 s2, 256
    s_cbranch_scc1 L_end
    s_and_b32 s62, s2, 7
    s_lshr_b32 s4, s62, 2
    s_mul_i32 s60, s4, 40
    s_add_u32 s60, s0, s60
    s_addc_u32 s61, s1, 0
    s_load_dwordx2 s[28:29], s[60:61], 0
    s_load_dwordx2 s[32:33], s[60:61], 24
    s_load_dwordx2 s[40:41], s[60:61], 8
    s_load_dwordx2 s[44:45], s[60:61], 16
    s_load_dwordx2 s[36:37], s[60:61], 32
    s_load_dwordx2 s[52:53], s[0:1], 80
    s_load_dwordx2 s[56:57], s[0:1], 88
    s_load_dwordx2 s[48:49], s[0:1], 96
    v_lshrrev_b32 v1, 6, v0
    v_and_b32 v0, 63, v0
    v_readfirstlane_b32 s3, v1
    s_bfe_u32 s5, s2, 0x10003
    s_lshr_b32 s13, s2, 4
    s_and_b32 s14, s13, 3
    s_lshr_b32 s13, s13, 2
    s_add_u32 s8, s14, s13
    s_and_b32 s8, s8, 3
    s_and_b32 s6, s62, 1
    s_lshl_b32 s6, s6, 2
    s_add_u32 s6, s6, s14
    s_bfe_u32 s7, s62, 0x10001
    s_lshl_b32 s7, s7, 2
    s_add_u32 s7, s7, s13
    s_lshl_b32 s9, s4, 3
    s_add_u32 s9, s9, s6
    s_lshr_b32 s10, s3, 2
    s_and_b32 s3, s3, 3
    s_lshl_b32 s77, s3, 10
    s_lshl_b32 s19, s9, 8
    s_add_u32 s19, s19, 0
    s_bfe_u32 s11, s2, 0x30004
    s_add_u32 s11, s11, 4
    s_mov_b32 s78, 8192
    s_mov_b32 s79, 0x402000
    s_mov_b32 s30, 3145728
    s_mov_b32 s31, 0x20000
    s_mov_b32 s34, 8388608
    s_mov_b32 s35, 0x20000
    s_mov_b32 s38, 8388608
    s_mov_b32 s39, 0x20000
    s_mov_b32 s42, 67108864
    s_mov_b32 s43, 0x20000
    s_mov_b32 s46, 67108864
    s_mov_b32 s47, 0x20000
    s_mov_b32 s50, 308281344
    s_mov_b32 s51, 0x20000
    s_mov_b32 s54, 6291456
    s_mov_b32 s55, 0x20000
    s_mov_b32 s58, 256
    s_mov_b32 s59, 0x20000
    v_lshrrev_b32 v1, 5, v0
    v_lshlrev_b32 v1, 6, v1
    v_bfe_u32 v2, v0, 2, 3
    v_and_b32 v3, 3, v0
    s_lshl_b32 s62, s3, 3
    v_add_u32 v4, s62, v2
    v_lshrrev_b32 v5, 2, v4
    v_sub_u32 v5, 0, v5
    v_and_b32 v5, 3, v5
    v_xor_b32 v5, v5, v3
    v_lshl_add_u32 v5, v5, 4, v1
    v_lshl_add_u32 v58, v4, 11, v5
    s_and_b32 s62, s3, 1
    s_lshl_b32 s63, s62, 1
    v_xor_b32 v5, s63, v3
    v_lshl_add_u32 v5, v5, 4, v1
    v_lshl_add_u32 v59, v4, 13, v5
    v_lshl_add_u32 v61, v4, 11, v5
    v_lshlrev_b32 v5, 4, v0
    v_add_u32 v60, s77, v5
    v_xor_b32 v5, s62, v3
    v_lshl_add_u32 v5, v5, 4, v1
    v_lshl_add_u32 v62, v4, 8, v5
    v_lshrrev_b32 v5, 2, v2
    v_lshlrev_b32 v5, 1, v5
    v_xor_b32 v5, v5, v3
    v_lshl_add_u32 v5, v5, 4, v1
    v_lshl_add_u32 v63, v4, 8, v5
    s_waitcnt lgkmcnt(0)
    s_and_b32 s23, s7, 4
    s_and_b32 s0, s7, 3
    s_lshl_b32 s0, s0, 1
    s_lshr_b32 s95, s9, 2
    s_and_b32 s60, s95, 1
    s_xor_b32 s60, s60, s5
    s_add_u32 s0, s0, s60
    s_lshl_b32 s95, s95, 3
    s_and_b32 s95, s95, 31
    s_lshl_b32 s0, s0, 8
    s_lshl_b32 s60, s23, 5
    s_add_u32 s0, s0, s60
    s_cmp_eq_u32 s5, 0
    s_cbranch_scc0 L_g2
    s_cmp_eq_u32 s10, 0
    s_cbranch_scc1 L_g1t0
    s_branch L_g1t1
L_g2:
    s_cmp_eq_u32 s10, 0
    s_cbranch_scc1 L_g2t0
    s_branch L_g2t1
L_g1t1:
    s_lshl_b32 s60, s5, 3
    s_add_u32 s60, s60, s7
    s_xor_b32 s60, s60, s95
    s_lshl_b32 s67, s60, 8
    s_mul_i32 s66, s6, 393216
    s_lshl_b32 s68, s8, 1
    s_add_u32 s68, s68, s5
    s_lshl_b32 s68, s68, 1
    s_mov_b32 s69, 16
    s_mov_b32 s65, 0
    s_mov_b32 s64, 0
    s_mov_b32 s76, 15
    s_mov_b32 s68, 0
    s_call_b64 s[24:25], F_IQ
    s_call_b64 s[24:25], F_IQ
    s_mul_i32 s68, s8, 14
    s_lshr_b32 s68, s68, 2
    s_mov_b32 s69, 14
    s_waitcnt vmcnt(10)
    s_barrier
    s_call_b64 s[24:25], F_IQ
L_ll_1:
    s_call_b64 s[24:25], F_IQ
    s_waitcnt vmcnt(20)
    s_barrier
    s_cmp_lt_u32 s65, 16
    s_cbranch_scc1 L_ll_1
    s_lshl_b32 s60, s5, 3
    s_add_u32 s60, s60, s7
    s_xor_b32 s60, s60, s95
    s_lshl_b32 s61, s6, 6
    s_add_u32 s60, s60, s61
    s_lshl_b32 s74, s60, 17
    s_lshl_b32 s75, s9, 13
    s_mov_b32 s76, s75
    s_mov_b32 s65, 0
    s_mov_b32 s64, 0
    s_call_b64 s[24:25], F_IA0
    s_waitcnt vmcnt(18)
    s_barrier
    s_call_b64 s[24:25], F_IAM
    s_waitcnt vmcnt(16)
    s_barrier
    s_call_b64 s[24:25], F_IAM
    s_waitcnt vmcnt(16)
    s_barrier
L_ll_2:
    s_cmp_eq_u32 s65, s11
    s_cbranch_scc1 L_lx_3
    s_call_b64 s[24:25], F_IAM
    s_waitcnt vmcnt(16)
L_lr_4:
    s_barrier
    s_cmp_lt_u32 s65, 15
    s_cbranch_scc1 L_ll_2
    s_branch L_ld_6
L_lx_3:
    s_lshl_b32 s62, s9, 4
    v_mov_b32 v5, s62
    s_mov_b32 s22, 0x40000
    s_cmp_lg_u32 s3, 0
    s_cbranch_scc1 L_ls_5
    buffer_load_dword v4, v5, s[56:59], 0 offen sc1
L_ls_5:
    s_call_b64 s[24:25], F_IAM
    s_waitcnt vmcnt(16)
    s_barrier
    s_call_b64 s[24:25], F_IAM
    s_waitcnt vmcnt(16)
    s_cmp_lg_u32 s3, 0
    s_cbranch_scc1 L_lr_4
L_lp_7:
    v_readfirstlane_b32 s60, v4
    s_cmp_ge_u32 s60, 16
    s_cbranch_scc1 L_lr_4
    s_sub_u32 s22, s22, 1
    s_cmp_eq_u32 s22, 0
    s_cbranch_scc1 L_lr_4
    s_sleep 8
    buffer_load_dword v4, v5, s[56:59], 0 offen sc1
    s_waitcnt vmcnt(0)
    s_branch L_lp_7
L_ld_6:
    s_call_b64 s[24:25], F_IAL
    s_waitcnt vmcnt(16)
    s_barrier
    s_lshl_b32 s60, s5, 3
    s_add_u32 s60, s60, s7
    s_add_u32 s60, s60, 16
    s_xor_b32 s60, s60, s95
    s_lshl_b32 s67, s60, 8
    s_mul_i32 s66, s6, 393216
    s_lshl_b32 s68, s8, 1
    s_add_u32 s68, s68, s5
    s_lshl_b32 s68, s68, 1
    s_mov_b32 s69, 16
    s_mov_b32 s65, 0
    s_mov_b32 s64, 0
    s_mov_b32 s76, 3
    s_mul_i32 s68, s8, 1
    s_call_b64 s[24:25], F_IQ
    s_waitcnt vmcnt(18)
    s_barrier
    s_call_b64 s[24:25], F_IQ
    s_waitcnt vmcnt(20)
    s_barrier
    s_call_b64 s[24:25], F_GADR
    s_call_b64 s[24:25], F_IQ
    s_waitcnt vmcnt(20)
    s_barrier
    s_mov_b32 s14, 16
    s_mov_b32 s15, 1
    s_mov_b32 s1, 2
    s_mov_b32 s17, 0
    s_call_b64 s[26:27], F_GEMM
    s_call_b64 s[24:25], F_PACKQ
    s_call_b64 s[24:25], F_ASET
    s_barrier
    s_mov_b32 s18, 1
    s_call_b64 s[26:27], F_ATT
    s_barrier
    s_mul_i32 s66, s9, 1572864
    s_add_u32 s66, s66, 33554432
    s_lshl_b32 s68, s8, 1
    s_lshl_b32 s69, s23, 1
    s_mov_b32 s65, 3
    s_mov_b32 s64, 122880
    s_call_b64 s[24:25], F_IO
    s_call_b64 s[24:25], F_EP0
    s_call_b64 s[24:25], F_EP1
    s_barrier
    s_call_b64 s[24:25], F_IO
    s_call_b64 s[24:25], F_EP2
    s_call_b64 s[24:25], F_EP3
    s_barrier
    s_call_b64 s[24:25], F_IO
    s_call_b64 s[24:25], F_EP4
    s_call_b64 s[24:25], F_EP5
    s_waitcnt vmcnt(26)
    s_barrier
    s_call_b64 s[24:25], F_FPRE
    s_call_b64 s[24:25], F_IO
    s_call_b64 s[24:25], F_EP6
    s_call_b64 s[24:25], F_EP7
    s_waitcnt vmcnt(26)
    s_barrier
    s_call_b64 s[24:25], F_IO
    s_call_b64 s[24:25], F_EP8
    s_call_b64 s[24:25], F_EP9
    s_waitcnt vmcnt(24)
    s_mov_b32 s21, 1
    s_lshl_b32 s20, 0xf00, s23
    s_call_b64 s[24:25], F_FCHK
    s_barrier
    s_call_b64 s[24:25], F_IO
    s_call_b64 s[24:25], F_EP10
    s_call_b64 s[24:25], F_EP11
    s_waitcnt vmcnt(26)
    s_barrier
    s_call_b64 s[24:25], F_IO
    s_waitcnt vmcnt(24)
    s_barrier
    s_waitcnt vmcnt(0)
    s_call_b64 s[24:25], F_IO
    s_barrier
    s_mov_b32 s17, 3
    s_call_b64 s[24:25], F_SIG
L_ll_8:
    s_call_b64 s[24:25], F_IO
    s_waitcnt vmcnt(20)
    s_barrier
    s_cmp_lt_u32 s65, 14
    s_cbranch_scc1 L_ll_8
    s_call_b64 s[24:25], F_FPRE
    s_call_b64 s[24:25], F_IO
    s_waitcnt vmcnt(20)
    s_barrier
    s_call_b64 s[24:25], F_IO
    s_waitcnt vmcnt(20)
    s_mov_b32 s21, 2
    s_lshl_b32 s20, 0xf, s23
    s_call_b64 s[24:25], F_FCHK
    s_barrier
    s_call_b64 s[24:25], F_IO
    s_waitcnt vmcnt(20)
    s_barrier
    s_call_b64 s[24:25], F_IO
    s_lshr_b32 s60, s2, 4
    s_lshr_b32 s70, s60, 3
    s_lshl_b32 s70, s70, 2
    s_add_u32 s70, s70, s3
    s_lshl_b32 s70, s70, 14
    s_and_b32 s60, s60, 7
    s_lshl_b32 s61, s23, 1
    s_add_u32 s60, s60, s61
    s_add_u32 s60, s60, 32
    s_lshl_b32 s60, s60, 17
    s_lshl_b32 s61, s95, 18
    s_xor_b32 s60, s60, s61
    s_add_u32 s70, s70, s60
    v_lshrrev_b32 v7, 3, v0
    v_lshlrev_b32 v7, 11, v7
    s_and_b32 s60, s0, 256
    s_xor_b32 s60, s60, 256
    v_bfe_u32 v6, v0, 1, 2
    v_lshl_add_u32 v7, v6, 9, v7
    v_and_b32 v6, 1, v0
    v_lshl_add_u32 v7, v6, 7, v7
    s_add_u32 s70, s70, s60
    buffer_load_dword v6, v7, s[36:39], s70 offen
    s_waitcnt vmcnt(21)
    s_barrier
    s_call_b64 s[24:25], F_IO
    s_waitcnt vmcnt(21)
    s_barrier
    s_call_b64 s[24:25], F_IO
    s_waitcnt vmcnt(21)
    s_barrier
    s_call_b64 s[24:25], F_IO
    s_waitcnt vmcnt(20)
    s_barrier
L_ll_9:
    s_call_b64 s[24:25], F_IO
    s_waitcnt vmcnt(20)
    s_barrier
    s_cmp_lt_u32 s65, 24
    s_cbranch_scc1 L_ll_9
    s_lshr_b32 s60, s2, 4
    s_add_u32 s60, s60, 48
    s_lshl_b32 s70, s3, 15
    s_lshl_b32 s60, s60, 17
    s_lshl_b32 s61, s95, 18
    s_xor_b32 s60, s60, s61
    s_add_u32 s70, s70, s60
    v_lshrrev_b32 v7, 3, v0
    v_lshlrev_b32 v7, 11, v7
    s_and_b32 s60, s0, 128
    v_and_b32 v6, 7, v0
    v_lshl_add_u32 v7, v6, 8, v7
    s_add_u32 s70, s70, s60
    buffer_load_dword v6, v7, s[36:39], s70 offen
    s_add_u32 s70, s70, 16384
    buffer_load_dword v6, v7, s[36:39], s70 offen
    s_waitcnt vmcnt(12)
    s_barrier
    s_waitcnt vmcnt(2)
    s_barrier
    s_mov_b32 s21, 2
    s_lshl_b32 s20, 0xf00, s23
    s_call_b64 s[24:25], F_FPRE
    s_waitcnt vmcnt(0)
    s_call_b64 s[24:25], F_FCHK
    s_barrier
    s_mul_i32 s66, s9, 1572864
    s_add_u32 s66, s66, 33554432
    s_lshl_b32 s68, s8, 1
    s_lshl_b32 s69, s23, 1
    s_mov_b32 s65, 0
    s_mov_b32 s64, 0
    s_call_b64 s[24:25], F_IT
    s_call_b64 s[24:25], F_IT
    s_waitcnt vmcnt(8)
    s_barrier
    s_call_b64 s[24:25], F_IT
L_tail_loader:
L_ll_10:
    s_call_b64 s[24:25], F_IT
    s_waitcnt vmcnt(16)
    s_barrier
    s_cmp_lt_u32 s65, 6
    s_cbranch_scc1 L_ll_10
    s_call_b64 s[24:25], F_FPRE
    s_call_b64 s[24:25], F_IT
    s_waitcnt vmcnt(16)
    s_barrier
    s_call_b64 s[24:25], F_IT
    s_waitcnt vmcnt(16)
    s_mov_b32 s21, 2
    s_xor_b32 s60, s23, 4
    s_lshl_b32 s20, 0xf00, s60
    s_call_b64 s[24:25], F_FCHK
    s_barrier
L_ll_11:
    s_call_b64 s[24:25], F_IT
    s_waitcnt vmcnt(16)
    s_barrier
    s_cmp_lt_u32 s65, 14
    s_cbranch_scc1 L_ll_11
    s_call_b64 s[24:25], F_FPRE
    s_call_b64 s[24:25], F_IT
    s_waitcnt vmcnt(16)
    s_barrier
    s_call_b64 s[24:25], F_IT
    s_waitcnt vmcnt(16)
    s_mov_b32 s21, 4
    s_lshl_b32 s60, s5, 3
    s_xor_b32 s61, s7, 4
    s_add_u32 s60, s60, s61
    s_lshl_b32 s20, 1, s60
    s_call_b64 s[24:25], F_FCHK
    s_barrier
    s_waitcnt vmcnt(8)
    s_barrier
    s_waitcnt vmcnt(0)
    s_barrier
    s_branch L_finish
L_g1t0:
    s_mov_b32 s17, 0
    s_call_b64 s[24:25], F_SIG
    s_cmp_lg_u32 s3, 0
    s_cbranch_scc1 L_if_12
    s_waitcnt vmcnt(0)
    s_lshl_b32 s60, s9, 4
    v_mov_b32 v7, s60
    v_mov_b32 v6, 1
    s_mov_b64 exec, 1
    buffer_atomic_add v6, v7, s[56:59], 0 offen sc1
    s_mov_b64 exec, -1
L_if_12:
    s_call_b64 s[24:25], F_GADR
    s_barrier
    s_mov_b32 s14, 16
    s_mov_b32 s15, 16
    s_mov_b32 s1, 16
    s_mov_b32 s17, 0
    s_call_b64 s[26:27], F_GEMM
    s_call_b64 s[24:25], F_PACKQ
    s_call_b64 s[24:25], F_ASET
    s_barrier
    s_mov_b32 s18, 0
    s_call_b64 s[26:27], F_ATT
    s_barrier
    s_lshl_b32 s60, s5, 3
    s_add_u32 s60, s60, s7
    s_add_u32 s60, s60, 16
    s_xor_b32 s60, s60, s95
    s_lshl_b32 s67, s60, 8
    s_mul_i32 s66, s6, 393216
    s_lshl_b32 s68, s8, 1
    s_add_u32 s68, s68, s5
    s_lshl_b32 s68, s68, 1
    s_mov_b32 s69, 16
    s_mov_b32 s65, 3
    s_mov_b32 s64, 122880
    s_mov_b32 s76, 3
    s_mul_i32 s68, s8, 1
    s_call_b64 s[24:25], F_IQ
    s_call_b64 s[24:25], F_EP0
    s_call_b64 s[24:25], F_EP1
    s_call_b64 s[24:25], F_EP2
    s_call_b64 s[24:25], F_EP3
    s_barrier
    s_call_b64 s[24:25], F_IQ
    s_call_b64 s[24:25], F_EP4
    s_call_b64 s[24:25], F_EP5
    s_call_b64 s[24:25], F_EP6
    s_call_b64 s[24:25], F_EP7
    s_barrier
    s_call_b64 s[24:25], F_IQ
    s_call_b64 s[24:25], F_EP8
    s_call_b64 s[24:25], F_EP9
    s_call_b64 s[24:25], F_EP10
    s_call_b64 s[24:25], F_EP11
    s_waitcnt vmcnt(32)
    s_barrier
    s_call_b64 s[24:25], F_IQ
    s_waitcnt vmcnt(28)
    s_barrier
    s_waitcnt vmcnt(0)
    s_call_b64 s[24:25], F_IQ
    s_barrier
    s_mov_b32 s17, 1
    s_call_b64 s[24:25], F_SIG
L_ll_13:
    s_call_b64 s[24:25], F_IQ
    s_waitcnt vmcnt(20)
    s_barrier
    s_cmp_lt_u32 s65, 10
    s_cbranch_scc1 L_ll_13
    s_call_b64 s[24:25], F_IQ
    s_lshl_b32 s60, s5, 3
    s_xor_b32 s60, s60, 0
    s_add_u32 s60, s60, s7
    s_add_u32 s60, s60, 0
    s_lshl_b32 s61, s9, 5
    s_add_u32 s60, s60, s61
    s_mul_i32 s70, s60, 49152
    s_add_u32 s70, s70, 33554432
    s_mul_i32 s60, s3, 12288
    s_add_u32 s70, s70, s60
    v_lshlrev_b32 v7, 7, v0
    buffer_load_dword v6, v7, s[48:51], s70 offen sc1
    s_add_u32 s70, s70, 4096
    buffer_load_dword v6, v7, s[48:51], s70 offen sc1
    s_waitcnt vmcnt(22)
    s_barrier
    s_call_b64 s[24:25], F_IQ
    s_waitcnt vmcnt(22)
    s_barrier
    s_call_b64 s[24:25], F_IQ
    s_waitcnt vmcnt(22)
    s_barrier
    s_call_b64 s[24:25], F_IQ
    s_waitcnt vmcnt(20)
    s_barrier
    s_call_b64 s[24:25], F_IQ
    s_waitcnt vmcnt(20)
    s_barrier
    s_call_b64 s[24:25], F_IQ
    s_lshl_b32 s60, s5, 3
    s_add_u32 s60, s60, s7
    s_add_u32 s60, s60, 16
    s_xor_b32 s60, s60, s95
    s_lshl_b32 s61, s6, 6
    s_add_u32 s60, s60, s61
    s_lshl_b32 s74, s60, 17
    s_lshl_b32 s75, s9, 13
    s_mul_i32 s60, s78, 10
    s_add_u32 s60, s60, s75
    s_and_b32 s60, s60, 0x1ffff
    s_add_u32 s70, s74, s60
    s_xor_b32 s71, s70, s79
    buffer_load_dwordx4 v[64:67], v63, s[44:47], s70 offen offset:0 nt
    buffer_load_dwordx4 v[68:71], v63, s[44:47], s70 offen offset:128 nt
    buffer_load_dwordx4 v[72:75], v63, s[44:47], s71 offen offset:0 nt
    buffer_load_dwordx4 v[76:79], v63, s[44:47], s71 offen offset:128 nt
    s_mul_i32 s60, s78, 12
    s_add_u32 s60, s60, s75
    s_and_b32 s60, s60, 0x1ffff
    s_add_u32 s70, s74, s60
    s_xor_b32 s71, s70, s79
    buffer_load_dwordx4 v[80:83], v62, s[40:43], s70 offen offset:0 nt
    buffer_load_dwordx4 v[84:87], v62, s[40:43], s70 offen offset:128 nt
    buffer_load_dwordx4 v[88:91], v62, s[40:43], s71 offen offset:0 nt
    buffer_load_dwordx4 v[92:95], v62, s[40:43], s71 offen offset:128 nt
    s_mul_i32 s60, s78, 12
    s_add_u32 s60, s60, s75
    s_and_b32 s60, s60, 0x1ffff
    s_add_u32 s70, s74, s60
    s_xor_b32 s71, s70, s79
    buffer_load_dwordx4 v[96:99], v63, s[44:47], s70 offen offset:0 nt
    buffer_load_dwordx4 v[100:103], v63, s[44:47], s70 offen offset:128 nt
    buffer_load_dwordx4 v[104:107], v63, s[44:47], s71 offen offset:0 nt
    buffer_load_dwordx4 v[108:111], v63, s[44:47], s71 offen offset:128 nt
    s_mul_i32 s60, s78, 14
    s_add_u32 s60, s60, s75
    s_and_b32 s60, s60, 0x1ffff
    s_add_u32 s70, s74, s60
    s_xor_b32 s71, s70, s79
    buffer_load_dwordx4 v[112:115], v62, s[40:43], s70 offen offset:0 nt
    buffer_load_dwordx4 v[116:119], v62, s[40:43], s70 offen offset:128 nt
    buffer_load_dwordx4 v[120:123], v62, s[40:43], s71 offen offset:0 nt
    buffer_load_dwordx4 v[124:127], v62, s[40:43], s71 offen offset:128 nt
    s_mul_i32 s60, s78, 14
    s_add_u32 s60, s60, s75
    s_and_b32 s60, s60, 0x1ffff
    s_add_u32 s70, s74, s60
    s_xor_b32 s71, s70, s79
    buffer_load_dwordx4 v[128:131], v63, s[44:47], s70 offen offset:0 nt
    buffer_load_dwordx4 v[132:135], v63, s[44:47], s70 offen offset:128 nt
    buffer_load_dwordx4 v[136:139], v63, s[44:47], s71 offen offset:0 nt
    buffer_load_dwordx4 v[140:143], v63, s[44:47], s71 offen offset:128 nt
    s_mul_i32 s60, s78, 15
    s_add_u32 s60, s60, s75
    s_and_b32 s60, s60, 0x1ffff
    s_add_u32 s70, s74, s60
    s_xor_b32 s71, s70, s79
    buffer_load_dwordx4 v[144:147], v63, s[44:47], s70 offen offset:0 nt
    buffer_load_dwordx4 v[148:151], v63, s[44:47], s70 offen offset:128 nt
    buffer_load_dwordx4 v[152:155], v63, s[44:47], s71 offen offset:0 nt
    buffer_load_dwordx4 v[156:159], v63, s[44:47], s71 offen offset:128 nt
    s_waitcnt vmcnt(44)
    s_barrier
    s_lshl_b32 s60, s5, 3
    s_add_u32 s60, s60, s7
    s_add_u32 s60, s60, 16
    s_xor_b32 s60, s60, s95
    s_lshl_b32 s61, s6, 6
    s_add_u32 s60, s60, s61
    s_lshl_b32 s74, s60, 17
    s_lshl_b32 s75, s9, 13
    s_mov_b32 s76, s75
    s_mov_b32 s65, 0
    s_mov_b32 s64, 0
    s_call_b64 s[24:25], F_IA0
    s_waitcnt vmcnt(42)
    s_barrier
    s_call_b64 s[24:25], F_IAM
    s_waitcnt vmcnt(40)
    s_barrier
    s_call_b64 s[24:25], F_IAM
    s_waitcnt vmcnt(16)
    s_barrier
L_ll_14:
    s_call_b64 s[24:25], F_IAM
    s_waitcnt vmcnt(16)
    s_barrier
    s_cmp_lt_u32 s65, 9
    s_cbranch_scc1 L_ll_14
    s_call_b64 s[24:25], F_FPRE
    s_call_b64 s[24:25], F_IAM
    s_waitcnt vmcnt(16)
    s_barrier
    s_call_b64 s[24:25], F_IAM
    s_waitcnt vmcnt(16)
    s_mov_b32 s21, 1
    s_lshl_b32 s20, 0xf, s23
    s_call_b64 s[24:25], F_FCHK
    s_barrier
    s_add_u32 s73, s64, s77
    v_add_u32 v1, s73, v60
    ds_write_b128 v1, v[64:67] offset:0
    ds_write_b128 v1, v[68:71] offset:1024
    ds_write_b128 v1, v[72:75] offset:8192
    ds_write_b128 v1, v[76:79] offset:9216
    ds_write_b128 v1, v[80:83] offset:16384
    s_call_b64 s[24:25], F_SKIP
    s_waitcnt vmcnt(8)
    s_barrier
    s_call_b64 s[24:25], F_IAM
    ds_write_b128 v1, v[84:87] offset:17408
    ds_write_b128 v1, v[88:91] offset:24576
    ds_write_b128 v1, v[92:95] offset:25600
    s_waitcnt vmcnt(8)
    s_barrier
    s_waitcnt lgkmcnt(0)
    s_add_u32 s73, s64, s77
    v_add_u32 v1, s73, v60
    ds_write_b128 v1, v[96:99] offset:0
    ds_write_b128 v1, v[100:103] offset:1024
    ds_write_b128 v1, v[104:107] offset:8192
    ds_write_b128 v1, v[108:111] offset:9216
    ds_write_b128 v1, v[112:115] offset:16384
    s_call_b64 s[24:25], F_SKIP
    s_barrier
    s_call_b64 s[24:25], F_IAM
    ds_write_b128 v1, v[116:119] offset:17408
    ds_write_b128 v1, v[120:123] offset:24576
    ds_write_b128 v1, v[124:127] offset:25600
    s_waitcnt vmcnt(8)
    s_barrier
    s_waitcnt lgkmcnt(0)
    s_add_u32 s73, s64, s77
    v_add_u32 v1, s73, v60
    ds_write_b128 v1, v[128:131] offset:0
    ds_write_b128 v1, v[132:135] offset:1024
    ds_write_b128 v1, v[136:139] offset:8192
    ds_write_b128 v1, v[140:143] offset:9216
    ds_write_b128 v1, v[144:147] offset:16384
    s_call_b64 s[24:25], F_SKIP
    s_barrier
    s_mul_i32 s66, s9, 1572864
    s_add_u32 s66, s66, 33554432
    s_lshl_b32 s68, s8, 1
    s_lshl_b32 s69, s23, 1
    s_mov_b32 s65, 0
    s_mov_b32 s64, 0
    s_call_b64 s[24:25], F_IO
    ds_write_b128 v1, v[148:151] offset:17408
    ds_write_b128 v1, v[152:155] offset:24576
    ds_write_b128 v1, v[156:159] offset:25600
    s_waitcnt vmcnt(10)
    s_barrier
    s_waitcnt lgkmcnt(0)
    s_call_b64 s[24:25], F_IO
    s_barrier
    s_call_b64 s[24:25], F_GADR
    s_call_b64 s[24:25], F_IO
    s_waitcnt vmcnt(20)
    s_barrier
    s_mov_b32 s14, 24
    s_mov_b32 s15, 1
    s_mov_b32 s1, 2
    s_mov_b32 s17, 0
    s_call_b64 s[26:27], F_GEMM
L_tail_compute:
    s_mul_i32 s12, s2, 49152
    s_mul_i32 s61, s3, 12288
    s_add_u32 s12, s12, s61
    s_add_u32 s12, s12, 67108864
    v_lshlrev_b32 v1, 4, v0
    v_cvt_pk_bf16_f32 v208, v160, v161
    v_cvt_pk_bf16_f32 v209, v162, v163
    v_cvt_pk_bf16_f32 v210, v164, v165
    v_cvt_pk_bf16_f32 v211, v166, v167
    buffer_store_dwordx4 v[208:211], v1, s[48:51], s12 offen offset:0 sc1
    v_cvt_pk_bf16_f32 v212, v168, v169
    v_cvt_pk_bf16_f32 v213, v170, v171
    v_cvt_pk_bf16_f32 v214, v172, v173
    v_cvt_pk_bf16_f32 v215, v174, v175
    buffer_store_dwordx4 v[212:215], v1, s[48:51], s12 offen offset:1024 sc1
    v_cvt_pk_bf16_f32 v216, v176, v177
    v_cvt_pk_bf16_f32 v217, v178, v179
    v_cvt_pk_bf16_f32 v218, v180, v181
    v_cvt_pk_bf16_f32 v219, v182, v183
    buffer_store_dwordx4 v[216:219], v1, s[48:51], s12 offen offset:2048 sc1
    v_cvt_pk_bf16_f32 v220, v184, v185
    v_cvt_pk_bf16_f32 v221, v186, v187
    v_cvt_pk_bf16_f32 v222, v188, v189
    v_cvt_pk_bf16_f32 v223, v190, v191
    buffer_store_dwordx4 v[220:223], v1, s[48:51], s12 offen offset:3072 sc1
    v_cvt_pk_bf16_f32 v224, v192, v193
    v_cvt_pk_bf16_f32 v225, v194, v195
    v_cvt_pk_bf16_f32 v226, v196, v197
    v_cvt_pk_bf16_f32 v227, v198, v199
    s_add_u32 s12, s12, 4096
    buffer_store_dwordx4 v[224:227], v1, s[48:51], s12 offen offset:0 sc1
    v_cvt_pk_bf16_f32 v228, v200, v201
    v_cvt_pk_bf16_f32 v229, v202, v203
    v_cvt_pk_bf16_f32 v230, v204, v205
    v_cvt_pk_bf16_f32 v231, v206, v207
    buffer_store_dwordx4 v[228:231], v1, s[48:51], s12 offen offset:1024 sc1
    s_call_b64 s[24:25], F_TADR
    v_and_b32 v54, 15, v0
    v_lshlrev_b32 v54, 12, v54
    v_lshrrev_b32 v52, 5, v0
    v_bfe_u32 v53, v0, 4, 1
    v_lshl_or_b32 v52, v53, 1, v52
    v_lshl_add_u32 v54, v52, 4, v54
    s_mul_i32 s70, s6, 192
    s_mul_i32 s61, s3, 48
    s_add_u32 s70, s70, s61
    s_lshl_b32 s70, s70, 12
    s_lshl_b32 s61, s4, 11
    s_add_u32 s70, s70, s61
    s_add_u32 s70, s70, s0
    s_cmp_eq_u32 s5, 1
    s_cbranch_scc1 L_tc2
    s_barrier
L_tc2:
    s_barrier
    s_mov_b32 s14, 16
    s_mov_b32 s15, 4
    s_mov_b32 s1, 13
    s_mov_b32 s17, 7
    s_call_b64 s[26:27], F_TAIL
    s_waitcnt vmcnt(0)
    v_lshlrev_b32 v160, 16, v232
    v_and_b32 v161, 0xffff0000, v232
    v_lshlrev_b32 v162, 16, v233
    v_and_b32 v163, 0xffff0000, v233
    v_pk_add_f32 v[112:113], v[112:113], v[160:161]
    v_pk_add_f32 v[114:115], v[114:115], v[162:163]
    v_lshlrev_b32 v172, 16, v238
    v_and_b32 v173, 0xffff0000, v238
    v_lshlrev_b32 v174, 16, v239
    v_and_b32 v175, 0xffff0000, v239
    v_pk_add_f32 v[124:125], v[124:125], v[172:173]
    v_pk_add_f32 v[126:127], v[126:127], v[174:175]
    v_lshlrev_b32 v184, 16, v244
    v_and_b32 v185, 0xffff0000, v244
    v_lshlrev_b32 v186, 16, v245
    v_and_b32 v187, 0xffff0000, v245
    v_pk_add_f32 v[136:137], v[136:137], v[184:185]
    v_pk_add_f32 v[138:139], v[138:139], v[186:187]
    v_lshlrev_b32 v196, 16, v250
    v_and_b32 v197, 0xffff0000, v250
    v_lshlrev_b32 v198, 16, v251
    v_and_b32 v199, 0xffff0000, v251
    v_pk_add_f32 v[148:149], v[148:149], v[196:197]
    v_pk_add_f32 v[150:151], v[150:151], v[198:199]
    v_cvt_pk_bf16_f32 v64, v112, v113
    v_cvt_pk_bf16_f32 v66, v124, v125
    v_cvt_pk_bf16_f32 v65, v114, v115
    v_cvt_pk_bf16_f32 v67, v126, v127
    v_cvt_pk_bf16_f32 v68, v136, v137
    v_cvt_pk_bf16_f32 v70, v148, v149
    v_cvt_pk_bf16_f32 v69, v138, v139
    v_cvt_pk_bf16_f32 v71, v150, v151
    v_permlane16_swap_b32 v64, v66
    v_permlane16_swap_b32 v65, v67
    s_nop 0
    v_permlane16_swap_b32 v68, v70
    v_permlane16_swap_b32 v69, v71
    buffer_store_dwordx4 v[64:67], v54, s[52:55], s70 offen offset:0 sc1
    buffer_store_dwordx4 v[68:71], v54, s[52:55], s70 offen offset:64 sc1
    s_add_u32 s70, s70, 65536
    v_lshlrev_b32 v164, 16, v234
    v_and_b32 v165, 0xffff0000, v234
    v_lshlrev_b32 v166, 16, v235
    v_and_b32 v167, 0xffff0000, v235
    v_pk_add_f32 v[116:117], v[116:117], v[164:165]
    v_pk_add_f32 v[118:119], v[118:119], v[166:167]
    v_lshlrev_b32 v176, 16, v240
    v_and_b32 v177, 0xffff0000, v240
    v_lshlrev_b32 v178, 16, v241
    v_and_b32 v179, 0xffff0000, v241
    v_pk_add_f32 v[128:129], v[128:129], v[176:177]
    v_pk_add_f32 v[130:131], v[130:131], v[178:179]
    v_lshlrev_b32 v188, 16, v246
    v_and_b32 v189, 0xffff0000, v246
    v_lshlrev_b32 v190, 16, v247
    v_and_b32 v191, 0xffff0000, v247
    v_pk_add_f32 v[140:141], v[140:141], v[188:189]
    v_pk_add_f32 v[142:143], v[142:143], v[190:191]
    v_lshlrev_b32 v200, 16, v252
    v_and_b32 v201, 0xffff0000, v252
    v_lshlrev_b32 v202, 16, v253
    v_and_b32 v203, 0xffff0000, v253
    v_pk_add_f32 v[152:153], v[152:153], v[200:201]
    v_pk_add_f32 v[154:155], v[154:155], v[202:203]
    v_cvt_pk_bf16_f32 v72, v116, v117
    v_cvt_pk_bf16_f32 v74, v128, v129
    v_cvt_pk_bf16_f32 v73, v118, v119
    v_cvt_pk_bf16_f32 v75, v130, v131
    v_cvt_pk_bf16_f32 v76, v140, v141
    v_cvt_pk_bf16_f32 v78, v152, v153
    v_cvt_pk_bf16_f32 v77, v142, v143
    v_cvt_pk_bf16_f32 v79, v154, v155
    v_permlane16_swap_b32 v72, v74
    v_permlane16_swap_b32 v73, v75
    s_nop 0
    v_permlane16_swap_b32 v76, v78
    v_permlane16_swap_b32 v77, v79
    buffer_store_dwordx4 v[72:75], v54, s[52:55], s70 offen offset:0 sc1
    buffer_store_dwordx4 v[76:79], v54, s[52:55], s70 offen offset:64 sc1
    s_add_u32 s70, s70, 65536
    v_lshlrev_b32 v168, 16, v236
    v_and_b32 v169, 0xffff0000, v236
    v_lshlrev_b32 v170, 16, v237
    v_and_b32 v171, 0xffff0000, v237
    v_pk_add_f32 v[120:121], v[120:121], v[168:169]
    v_pk_add_f32 v[122:123], v[122:123], v[170:171]
    v_lshlrev_b32 v180, 16, v242
    v_and_b32 v181, 0xffff0000, v242
    v_lshlrev_b32 v182, 16, v243
    v_and_b32 v183, 0xffff0000, v243
    v_pk_add_f32 v[132:133], v[132:133], v[180:181]
    v_pk_add_f32 v[134:135], v[134:135], v[182:183]
    v_lshlrev_b32 v192, 16, v248
    v_and_b32 v193, 0xffff0000, v248
    v_lshlrev_b32 v194, 16, v249
    v_and_b32 v195, 0xffff0000, v249
    v_pk_add_f32 v[144:145], v[144:145], v[192:193]
    v_pk_add_f32 v[146:147], v[146:147], v[194:195]
    v_lshlrev_b32 v204, 16, v254
    v_and_b32 v205, 0xffff0000, v254
    v_lshlrev_b32 v206, 16, v255
    v_and_b32 v207, 0xffff0000, v255
    v_pk_add_f32 v[156:157], v[156:157], v[204:205]
    v_pk_add_f32 v[158:159], v[158:159], v[206:207]
    v_cvt_pk_bf16_f32 v80, v120, v121
    v_cvt_pk_bf16_f32 v82, v132, v133
    v_cvt_pk_bf16_f32 v81, v122, v123
    v_cvt_pk_bf16_f32 v83, v134, v135
    v_cvt_pk_bf16_f32 v84, v144, v145
    v_cvt_pk_bf16_f32 v86, v156, v157
    v_cvt_pk_bf16_f32 v85, v146, v147
    v_cvt_pk_bf16_f32 v87, v158, v159
    v_permlane16_swap_b32 v80, v82
    v_permlane16_swap_b32 v81, v83
    s_nop 0
    v_permlane16_swap_b32 v84, v86
    v_permlane16_swap_b32 v85, v87
    buffer_store_dwordx4 v[80:83], v54, s[52:55], s70 offen offset:0 sc1
    buffer_store_dwordx4 v[84:87], v54, s[52:55], s70 offen offset:64 sc1
    s_branch L_finish
L_g2t0:
    s_mov_b32 s17, 0
    s_call_b64 s[24:25], F_SIG
    s_cmp_lg_u32 s3, 0
    s_cbranch_scc1 L_if_15
    s_waitcnt vmcnt(0)
    s_lshl_b32 s60, s9, 4
    v_mov_b32 v7, s60
    v_mov_b32 v6, 1
    s_mov_b64 exec, 1
    buffer_atomic_add v6, v7, s[56:59], 0 offen sc1
    s_mov_b64 exec, -1
L_if_15:
    s_call_b64 s[24:25], F_GADR
    s_barrier
    s_mov_b32 s14, 16
    s_mov_b32 s15, 16
    s_mov_b32 s1, 16
    s_mov_b32 s17, 0
    s_call_b64 s[26:27], F_GEMM
    s_call_b64 s[24:25], F_PACKQ
    s_barrier
    s_mov_b32 s14, 16
    s_mov_b32 s15, 16
    s_mov_b32 s1, 16
    s_mov_b32 s17, 0
    s_call_b64 s[26:27], F_GEMM
    s_mul_i32 s60, s3, 11264
    s_add_u32 s60, s60, 114688
    v_add_u32 v4, s60, v60
    s_barrier
    ds_write_b128 v4, v[208:211] offset:0
    ds_write_b128 v4, v[212:215] offset:1024
    ds_write_b128 v4, v[216:219] offset:2048
    ds_write_b128 v4, v[220:223] offset:3072
    ds_write_b128 v4, v[224:227] offset:4096
    ds_write_b128 v4, v[228:231] offset:5120
    ds_write_b128 v4, v[232:235] offset:6144
    ds_write_b128 v4, v[236:239] offset:7168
    ds_write_b128 v4, v[240:243] offset:8192
    ds_write_b128 v4, v[244:247] offset:9216
    ds_write_b128 v4, v[248:251] offset:10240
    ds_write_b128 v4, v[252:255] offset:11264
    s_call_b64 s[24:25], F_ASET
    s_waitcnt lgkmcnt(0)
    s_call_b64 s[24:25], F_PACKQ
    s_barrier
    s_mov_b32 s18, 0
    s_call_b64 s[26:27], F_ATT
    s_call_b64 s[24:25], F_EPACK
    v_bfe_u32 v7, v0, 3, 1
    s_mul_i32 s60, s3, 6
    v_add_u32 v7, s60, v7
    v_lshlrev_b32 v7, 10, v7
    v_and_b32 v52, 7, v0
    v_lshl_add_u32 v7, v52, 6, v7
    v_lshrrev_b32 v53, 5, v0
    v_bfe_u32 v52, v0, 4, 1
    v_lshl_or_b32 v53, v52, 1, v53
    v_lshrrev_b32 v52, 2, v0
    v_sub_u32 v52, 0, v52
    v_and_b32 v52, 3, v52
    v_xor_b32 v52, v52, v53
    v_lshl_add_u32 v7, v52, 4, v7
    s_lshl_b32 s60, s5, 3
    s_add_u32 s60, s60, s7
    s_lshl_b32 s61, s9, 5
    s_add_u32 s60, s60, s61
    s_mul_i32 s70, s60, 49152
    s_add_u32 s70, s70, 33554432
    s_call_b64 s[24:25], F_GADR
    s_barrier
    s_mov_b32 s14, 8
    s_mov_b32 s15, 2
    s_mov_b32 s1, 7
    s_mov_b32 s17, 64
    s_call_b64 s[26:27], F_GEMM
    s_barrier
    s_lshl_b32 s60, s5, 3
    s_add_u32 s60, s60, s7
    s_add_u32 s60, s60, 16
    s_xor_b32 s60, s60, s95
    s_lshl_b32 s61, s6, 6
    s_add_u32 s60, s60, s61
    s_lshl_b32 s74, s60, 17
    s_lshl_b32 s75, s9, 13
    s_mov_b32 s76, s75
    s_mov_b32 s65, 3
    s_mov_b32 s64, 122880
    s_mul_i32 s60, s78, 4
    s_add_u32 s75, s75, s60
    s_and_b32 s75, s75, 0x1ffff
    s_mul_i32 s60, s78, 2
    s_add_u32 s76, s76, s60
    s_and_b32 s76, s76, 0x1ffff
    s_call_b64 s[24:25], F_IAM
    s_barrier
    s_call_b64 s[24:25], F_IAM
    s_barrier
L_ll_16:
    s_call_b64 s[24:25], F_IAM
    s_waitcnt vmcnt(16)
    s_barrier
    s_cmp_lt_u32 s65, 14
    s_cbranch_scc1 L_ll_16
    s_call_b64 s[24:25], F_FPRE
    s_call_b64 s[24:25], F_IAM
    s_waitcnt vmcnt(16)
    s_barrier
    s_call_b64 s[24:25], F_IAL
    s_waitcnt vmcnt(16)
    s_mov_b32 s21, 1
    s_lshl_b32 s20, 0xf00, s23
    s_call_b64 s[24:25], F_FCHK
    s_barrier
    s_mul_i32 s66, s9, 1572864
    s_add_u32 s66, s66, 33554432
    s_lshl_b32 s68, s8, 1
    s_lshl_b32 s69, s23, 1
    s_mov_b32 s65, 8
    s_mov_b32 s64, 0
    s_call_b64 s[24:25], F_IO
    s_waitcnt vmcnt(18)
    s_barrier
    s_call_b64 s[24:25], F_IO
    s_waitcnt vmcnt(20)
    s_barrier
    s_call_b64 s[24:25], F_GADR
    s_call_b64 s[24:25], F_IO
    s_waitcnt vmcnt(20)
    s_barrier
    s_mov_b32 s14, 16
    s_mov_b32 s15, 1
    s_mov_b32 s1, 2
    s_mov_b32 s17, 0
    s_call_b64 s[26:27], F_GEMMC
    s_branch L_tail_compute
L_g2t1:
    s_lshl_b32 s60, s5, 3
    s_add_u32 s60, s60, s7
    s_xor_b32 s60, s60, s95
    s_lshl_b32 s61, s6, 6
    s_add_u32 s60, s60, s61
    s_lshl_b32 s74, s60, 17
    s_lshl_b32 s75, s9, 13
    s_lshl_b32 s60, s5, 3
    s_add_u32 s60, s60, s7
    s_add_u32 s60, s60, 16
    s_xor_b32 s60, s60, s95
    s_lshl_b32 s67, s60, 8
    s_mul_i32 s66, s6, 393216
    s_lshl_b32 s68, s8, 1
    s_add_u32 s68, s68, s5
    s_lshl_b32 s68, s68, 1
    s_mov_b32 s69, 16
    s_mov_b32 s65, 0
    s_mov_b32 s64, 0
    s_mov_b32 s76, 15
    s_mov_b32 s68, 0
    s_call_b64 s[24:25], F_IQ
    s_call_b64 s[24:25], F_IQ
    s_waitcnt vmcnt(10)
    s_barrier
    s_call_b64 s[24:25], F_IQ
    s_call_b64 s[24:25], F_IQ
    s_waitcnt vmcnt(20)
    s_barrier
    s_mov_b32 s76, 3
    s_mov_b32 s68, s8
    s_call_b64 s[24:25], F_IQ
    s_waitcnt vmcnt(20)
    s_barrier
    s_call_b64 s[24:25], F_IQ
    s_waitcnt vmcnt(20)
    s_barrier
    s_call_b64 s[24:25], F_IQ
    s_waitcnt vmcnt(20)
    s_barrier
    s_call_b64 s[24:25], F_IQ
    s_mul_i32 s60, s78, 9
    s_add_u32 s60, s60, s75
    s_and_b32 s60, s60, 0x1ffff
    s_add_u32 s70, s74, s60
    s_xor_b32 s71, s70, s79
    buffer_load_dwordx4 v[64:67], v63, s[44:47], s70 offen offset:0 nt
    buffer_load_dwordx4 v[68:71], v63, s[44:47], s70 offen offset:128 nt
    buffer_load_dwordx4 v[72:75], v63, s[44:47], s71 offen offset:0 nt
    buffer_load_dwordx4 v[76:79], v63, s[44:47], s71 offen offset:128 nt
    s_mul_i32 s60, s78, 11
    s_add_u32 s60, s60, s75
    s_and_b32 s60, s60, 0x1ffff
    s_add_u32 s70, s74, s60
    s_xor_b32 s71, s70, s79
    buffer_load_dwordx4 v[80:83], v62, s[40:43], s70 offen offset:0 nt
    buffer_load_dwordx4 v[84:87], v62, s[40:43], s70 offen offset:128 nt
    buffer_load_dwordx4 v[88:91], v62, s[40:43], s71 offen offset:0 nt
    buffer_load_dwordx4 v[92:95], v62, s[40:43], s71 offen offset:128 nt
    s_mul_i32 s60, s78, 10
    s_add_u32 s60, s60, s75
    s_and_b32 s60, s60, 0x1ffff
    s_add_u32 s70, s74, s60
    s_xor_b32 s71, s70, s79
    buffer_load_dwordx4 v[96:99], v63, s[44:47], s70 offen offset:0 nt
    buffer_load_dwordx4 v[100:103], v63, s[44:47], s70 offen offset:128 nt
    buffer_load_dwordx4 v[104:107], v63, s[44:47], s71 offen offset:0 nt
    buffer_load_dwordx4 v[108:111], v63, s[44:47], s71 offen offset:128 nt
    s_mul_i32 s60, s78, 12
    s_add_u32 s60, s60, s75
    s_and_b32 s60, s60, 0x1ffff
    s_add_u32 s70, s74, s60
    s_xor_b32 s71, s70, s79
    buffer_load_dwordx4 v[112:115], v62, s[40:43], s70 offen offset:0 nt
    buffer_load_dwordx4 v[116:119], v62, s[40:43], s70 offen offset:128 nt
    buffer_load_dwordx4 v[120:123], v62, s[40:43], s71 offen offset:0 nt
    buffer_load_dwordx4 v[124:127], v62, s[40:43], s71 offen offset:128 nt
    s_mul_i32 s60, s78, 11
    s_add_u32 s60, s60, s75
    s_and_b32 s60, s60, 0x1ffff
    s_add_u32 s70, s74, s60
    s_xor_b32 s71, s70, s79
    buffer_load_dwordx4 v[128:131], v63, s[44:47], s70 offen offset:0 nt
    buffer_load_dwordx4 v[132:135], v63, s[44:47], s70 offen offset:128 nt
    buffer_load_dwordx4 v[136:139], v63, s[44:47], s71 offen offset:0 nt
    buffer_load_dwordx4 v[140:143], v63, s[44:47], s71 offen offset:128 nt
    s_mul_i32 s60, s78, 13
    s_add_u32 s60, s60, s75
    s_and_b32 s60, s60, 0x1ffff
    s_add_u32 s70, s74, s60
    s_xor_b32 s71, s70, s79
    buffer_load_dwordx4 v[144:147], v62, s[40:43], s70 offen offset:0 nt
    buffer_load_dwordx4 v[148:151], v62, s[40:43], s70 offen offset:128 nt
    buffer_load_dwordx4 v[152:155], v62, s[40:43], s71 offen offset:0 nt
    buffer_load_dwordx4 v[156:159], v62, s[40:43], s71 offen offset:128 nt
    s_waitcnt vmcnt(44)
    s_mul_i32 s60, s78, 12
    s_add_u32 s60, s60, s75
    s_and_b32 s60, s60, 0x1ffff
    s_add_u32 s70, s74, s60
    s_xor_b32 s71, s70, s79
    buffer_load_dwordx4 v[160:163], v63, s[44:47], s70 offen offset:0 nt
    buffer_load_dwordx4 v[164:167], v63, s[44:47], s70 offen offset:128 nt
    buffer_load_dwordx4 v[168:171], v63, s[44:47], s71 offen offset:0 nt
    buffer_load_dwordx4 v[172:175], v63, s[44:47], s71 offen offset:128 nt
    s_mul_i32 s60, s78, 14
    s_add_u32 s60, s60, s75
    s_and_b32 s60, s60, 0x1ffff
    s_add_u32 s70, s74, s60
    s_xor_b32 s71, s70, s79
    buffer_load_dwordx4 v[176:179], v62, s[40:43], s70 offen offset:0 nt
    buffer_load_dwordx4 v[180:183], v62, s[40:43], s70 offen offset:128 nt
    buffer_load_dwordx4 v[184:187], v62, s[40:43], s71 offen offset:0 nt
    buffer_load_dwordx4 v[188:191], v62, s[40:43], s71 offen offset:128 nt
    s_waitcnt vmcnt(42)
    s_mul_i32 s60, s78, 14
    s_add_u32 s60, s60, s75
    s_and_b32 s60, s60, 0x1ffff
    s_add_u32 s70, s74, s60
    s_xor_b32 s71, s70, s79
    buffer_load_dwordx4 v[192:195], v63, s[44:47], s70 offen offset:0 nt
    buffer_load_dwordx4 v[196:199], v63, s[44:47], s70 offen offset:128 nt
    buffer_load_dwordx4 v[200:203], v63, s[44:47], s71 offen offset:0 nt
    buffer_load_dwordx4 v[204:207], v63, s[44:47], s71 offen offset:128 nt
    s_mul_i32 s60, s78, 15
    s_add_u32 s60, s60, s75
    s_and_b32 s60, s60, 0x1ffff
    s_add_u32 s70, s74, s60
    s_xor_b32 s71, s70, s79
    buffer_load_dwordx4 v[8:11], v63, s[44:47], s70 offen offset:0 nt
    buffer_load_dwordx4 v[12:15], v63, s[44:47], s70 offen offset:128 nt
    buffer_load_dwordx4 v[16:19], v63, s[44:47], s71 offen offset:0 nt
    buffer_load_dwordx4 v[20:23], v63, s[44:47], s71 offen offset:128 nt
    s_barrier
    s_waitcnt vmcnt(40)
    s_call_b64 s[24:25], F_IQ
    s_barrier
    s_waitcnt vmcnt(42)
    s_call_b64 s[24:25], F_IQ
    s_barrier
    s_waitcnt vmcnt(44)
    s_call_b64 s[24:25], F_IQ
    s_waitcnt vmcnt(20)
    s_barrier
L_ll_17:
    s_call_b64 s[24:25], F_IQ
    s_waitcnt vmcnt(20)
    s_barrier
    s_cmp_lt_u32 s65, 16
    s_cbranch_scc1 L_ll_17
    s_lshl_b32 s60, s5, 3
    s_add_u32 s60, s60, s7
    s_xor_b32 s60, s60, s95
    s_lshl_b32 s67, s60, 8
    s_mul_i32 s66, s6, 393216
    s_lshl_b32 s68, s8, 1
    s_add_u32 s68, s68, s5
    s_lshl_b32 s68, s68, 1
    s_mov_b32 s69, 16
    s_mov_b32 s65, 0
    s_mov_b32 s64, 0
    s_mov_b32 s76, 3
    s_mul_i32 s68, s8, 1
    s_call_b64 s[24:25], F_IQ
    s_waitcnt vmcnt(20)
    s_barrier
    s_call_b64 s[24:25], F_IQ
    s_waitcnt vmcnt(20)
    s_barrier
L_ll_18:
    s_cmp_eq_u32 s65, s11
    s_cbranch_scc1 L_lx_19
    s_call_b64 s[24:25], F_IQ
    s_waitcnt vmcnt(20)
L_lr_20:
    s_barrier
    s_cmp_lt_u32 s65, 16
    s_cbranch_scc1 L_ll_18
    s_branch L_ld_22
L_lx_19:
    s_lshl_b32 s62, s9, 4
    v_mov_b32 v5, s62
    s_mov_b32 s22, 0x40000
    s_cmp_lg_u32 s3, 0
    s_cbranch_scc1 L_ls_21
    buffer_load_dword v4, v5, s[56:59], 0 offen sc1
L_ls_21:
    s_call_b64 s[24:25], F_IQ
    s_waitcnt vmcnt(20)
    s_barrier
    s_call_b64 s[24:25], F_IQ
    s_waitcnt vmcnt(20)
    s_cmp_lg_u32 s3, 0
    s_cbranch_scc1 L_lr_20
L_lp_23:
    v_readfirstlane_b32 s60, v4
    s_cmp_ge_u32 s60, 16
    s_cbranch_scc1 L_lr_20
    s_sub_u32 s22, s22, 1
    s_cmp_eq_u32 s22, 0
    s_cbranch_scc1 L_lr_20
    s_sleep 8
    buffer_load_dword v4, v5, s[56:59], 0 offen sc1
    s_waitcnt vmcnt(0)
    s_branch L_lp_23
L_ld_22:
    s_lshl_b32 s60, s5, 3
    s_add_u32 s60, s60, s7
    s_xor_b32 s60, s60, s95
    s_lshl_b32 s61, s6, 6
    s_add_u32 s60, s60, s61
    s_lshl_b32 s74, s60, 17
    s_lshl_b32 s75, s9, 13
    s_mov_b32 s76, s75
    s_mov_b32 s65, 0
    s_mov_b32 s64, 0
    s_call_b64 s[24:25], F_IA0
    s_waitcnt vmcnt(18)
    s_barrier
    s_call_b64 s[24:25], F_IAM
    s_waitcnt vmcnt(16)
    s_barrier
    s_call_b64 s[24:25], F_IAM
    s_mul_i32 s60, s3, 11264
    s_add_u32 s60, s60, 114688
    v_add_u32 v4, s60, v60
    s_barrier
    s_waitcnt vmcnt(16)
    s_barrier
    ds_read_b128 v[208:211], v4 offset:0
    ds_read_b128 v[212:215], v4 offset:1024
    ds_read_b128 v[216:219], v4 offset:2048
    ds_read_b128 v[220:223], v4 offset:3072
    ds_read_b128 v[224:227], v4 offset:4096
    ds_read_b128 v[228:231], v4 offset:5120
    ds_read_b128 v[232:235], v4 offset:6144
    ds_read_b128 v[236:239], v4 offset:7168
    ds_read_b128 v[240:243], v4 offset:8192
    ds_read_b128 v[244:247], v4 offset:9216
    ds_read_b128 v[248:251], v4 offset:10240
    ds_read_b128 v[252:255], v4 offset:11264
    s_waitcnt lgkmcnt(0)
    s_waitcnt vmcnt(8)
    s_barrier
    s_call_b64 s[24:25], F_IAM
L_ll_24:
    s_call_b64 s[24:25], F_IAM
    s_waitcnt vmcnt(16)
    s_barrier
    s_cmp_lt_u32 s65, 10
    s_cbranch_scc1 L_ll_24
    s_add_u32 s73, s64, s77
    v_add_u32 v1, s73, v60
    ds_write_b128 v1, v[64:67] offset:0
    ds_write_b128 v1, v[68:71] offset:1024
    ds_write_b128 v1, v[72:75] offset:8192
    ds_write_b128 v1, v[76:79] offset:9216
    ds_write_b128 v1, v[80:83] offset:16384
    s_call_b64 s[24:25], F_SKIP
    s_waitcnt vmcnt(8)
    s_barrier
    ds_write_b128 v1, v[84:87] offset:17408
    ds_write_b128 v1, v[88:91] offset:24576
    ds_write_b128 v1, v[92:95] offset:25600
    s_add_u32 s73, s64, s77
    v_add_u32 v1, s73, v60
    ds_write_b128 v1, v[96:99] offset:0
    ds_write_b128 v1, v[100:103] offset:1024
    ds_write_b128 v1, v[104:107] offset:8192
    ds_write_b128 v1, v[108:111] offset:9216
    ds_write_b128 v1, v[112:115] offset:16384
    s_call_b64 s[24:25], F_SKIP
    s_waitcnt vmcnt(0)
    s_barrier
    s_call_b64 s[24:25], F_FPRE
    s_waitcnt lgkmcnt(0)
    ds_write_b128 v1, v[116:119] offset:17408
    ds_write_b128 v1, v[120:123] offset:24576
    ds_write_b128 v1, v[124:127] offset:25600
    s_add_u32 s73, s64, s77
    v_add_u32 v1, s73, v60
    ds_write_b128 v1, v[128:131] offset:0
    ds_write_b128 v1, v[132:135] offset:1024
    ds_write_b128 v1, v[136:139] offset:8192
    ds_write_b128 v1, v[140:143] offset:9216
    ds_write_b128 v1, v[144:147] offset:16384
    s_call_b64 s[24:25], F_SKIP
    s_cmp_lg_u32 s3, 0
    s_cbranch_scc1 L_c0_25
    s_waitcnt vmcnt(0)
    s_mov_b32 s21, 1
    s_lshl_b32 s20, 0xf, s23
    s_call_b64 s[24:25], F_FCHK
L_c0_25:
    s_barrier
    s_waitcnt lgkmcnt(0)
    ds_write_b128 v1, v[148:151] offset:17408
    ds_write_b128 v1, v[152:155] offset:24576
    ds_write_b128 v1, v[156:159] offset:25600
    s_add_u32 s73, s64, s77
    v_add_u32 v1, s73, v60
    ds_write_b128 v1, v[160:163] offset:0
    ds_write_b128 v1, v[164:167] offset:1024
    ds_write_b128 v1, v[168:171] offset:8192
    ds_write_b128 v1, v[172:175] offset:9216
    ds_write_b128 v1, v[176:179] offset:16384
    s_call_b64 s[24:25], F_SKIP
    s_barrier
    s_waitcnt lgkmcnt(0)
    s_call_b64 s[24:25], F_IAM
    ds_write_b128 v1, v[180:183] offset:17408
    ds_write_b128 v1, v[184:187] offset:24576
    ds_write_b128 v1, v[188:191] offset:25600
    s_barrier
    s_waitcnt lgkmcnt(0)
    s_add_u32 s73, s64, s77
    v_add_u32 v1, s73, v60
    ds_write_b128 v1, v[192:195] offset:0
    ds_write_b128 v1, v[196:199] offset:1024
    ds_write_b128 v1, v[200:203] offset:8192
    ds_write_b128 v1, v[204:207] offset:9216
    ds_write_b128 v1, v[8:11] offset:16384
    s_call_b64 s[24:25], F_SKIP
    s_barrier
    s_mul_i32 s66, s9, 1572864
    s_add_u32 s66, s66, 33554432
    s_lshl_b32 s68, s8, 1
    s_lshl_b32 s69, s23, 1
    s_mov_b32 s65, 0
    s_mov_b32 s64, 0
    s_call_b64 s[24:25], F_IO
    ds_write_b128 v1, v[12:15] offset:17408
    ds_write_b128 v1, v[16:19] offset:24576
    ds_write_b128 v1, v[20:23] offset:25600
    s_waitcnt vmcnt(10)
    s_barrier
    s_waitcnt lgkmcnt(0)
    s_call_b64 s[24:25], F_IO
    s_barrier
L_ll_26:
    s_call_b64 s[24:25], F_IO
    s_waitcnt vmcnt(20)
    s_barrier
    s_cmp_lt_u32 s65, 8
    s_cbranch_scc1 L_ll_26
    s_lshl_b32 s60, s5, 3
    s_add_u32 s60, s60, s7
    s_add_u32 s60, s60, 16
    s_xor_b32 s60, s60, s95
    s_lshl_b32 s61, s6, 6
    s_add_u32 s60, s60, s61
    s_lshl_b32 s74, s60, 17
    s_lshl_b32 s75, s9, 13
    s_mov_b32 s76, s75
    s_mov_b32 s65, 0
    s_mov_b32 s64, 0
    s_call_b64 s[24:25], F_IA0
    s_waitcnt vmcnt(18)
    s_barrier
    s_call_b64 s[24:25], F_IAM
    s_waitcnt vmcnt(16)
    s_barrier
    s_call_b64 s[24:25], F_ASET
    s_call_b64 s[24:25], F_IAM
    s_waitcnt vmcnt(16)
    s_barrier
    s_mov_b32 s18, 1
    s_call_b64 s[26:27], F_ATT
    s_barrier
    s_mul_i32 s66, s9, 1572864
    s_add_u32 s66, s66, 33554432
    s_lshl_b32 s68, s8, 1
    s_lshl_b32 s69, s23, 1
    s_mov_b32 s65, 11
    s_mov_b32 s64, 122880
    s_call_b64 s[24:25], F_IO
    s_call_b64 s[24:25], F_EP0
    s_call_b64 s[24:25], F_EP1
    s_barrier
    s_call_b64 s[24:25], F_IO
    s_call_b64 s[24:25], F_EP2
    s_call_b64 s[24:25], F_EP3
    s_barrier
    s_call_b64 s[24:25], F_IO
    s_call_b64 s[24:25], F_EP4
    s_call_b64 s[24:25], F_EP5
    s_waitcnt vmcnt(26)
    s_barrier
    s_call_b64 s[24:25], F_FPRE
    s_call_b64 s[24:25], F_IO
    s_call_b64 s[24:25], F_EP6
    s_call_b64 s[24:25], F_EP7
    s_waitcnt vmcnt(26)
    s_barrier
    s_call_b64 s[24:25], F_IO
    s_call_b64 s[24:25], F_EP8
    s_call_b64 s[24:25], F_EP9
    s_waitcnt vmcnt(24)
    s_mov_b32 s21, 2
    s_lshl_b32 s20, 0xf, s23
    s_call_b64 s[24:25], F_FCHK
    s_barrier
    s_call_b64 s[24:25], F_IO
    s_call_b64 s[24:25], F_EP10
    s_call_b64 s[24:25], F_EP11
    s_waitcnt vmcnt(26)
    s_barrier
    s_call_b64 s[24:25], F_IO
    s_waitcnt vmcnt(24)
    s_barrier
    s_waitcnt vmcnt(0)
    s_call_b64 s[24:25], F_IO
    s_barrier
    s_mov_b32 s17, 3
    s_call_b64 s[24:25], F_SIG
L_ll_27:
    s_call_b64 s[24:25], F_IO
    s_waitcnt vmcnt(20)
    s_barrier
    s_cmp_lt_u32 s65, 21
    s_cbranch_scc1 L_ll_27
    s_waitcnt vmcnt(0)
    s_call_b64 s[24:25], F_IO
    s_barrier
    s_call_b64 s[24:25], F_FPRE
    s_call_b64 s[24:25], F_IO
    s_waitcnt vmcnt(20)
    s_barrier
    s_call_b64 s[24:25], F_IO
    s_waitcnt vmcnt(20)
    s_mov_b32 s21, 2
    s_lshl_b32 s20, 0xf00, s23
    s_call_b64 s[24:25], F_FCHK
    s_barrier
    s_mul_i32 s66, s9, 1572864
    s_add_u32 s66, s66, 33554432
    s_lshl_b32 s68, s8, 1
    s_lshl_b32 s69, s23, 1
    s_mov_b32 s65, 0
    s_mov_b32 s64, 0
    s_call_b64 s[24:25], F_IT
    s_waitcnt vmcnt(18)
    s_barrier
    s_call_b64 s[24:25], F_IT
    s_waitcnt vmcnt(16)
    s_barrier
    s_call_b64 s[24:25], F_IT
    s_waitcnt vmcnt(16)
    s_barrier
    s_branch L_tail_loader
F_IQ:
    s_add_u32 s60, s65, s68
    s_cmp_ge_u32 s60, 16
    s_cselect_b32 s61, s69, 0
    s_sub_u32 s60, s60, s61
    s_and_b32 s60, s60, s76
    s_andn2_b32 s61, s65, s76
    s_or_b32 s60, s60, s61
    s_lshl_b32 s70, s60, 7
    s_add_u32 s70, s70, s66
    s_lshl_b32 s71, s60, 19
    s_add_u32 s71, s71, s67
    s_add_u32 s73, s64, s77
    s_add_u32 m0, s73, 0
    s_xor_b32 s72, s71, 128
    buffer_load_dwordx4 v58, s[28:31], s70 offen  lds
    s_add_u32 m0, s73, 4096
    s_add_u32 s70, s70, 65536
    buffer_load_dwordx4 v58, s[28:31], s70 offen  lds
    s_add_u32 m0, s73, 8192
    s_add_u32 s70, s70, 65536
    buffer_load_dwordx4 v58, s[28:31], s70 offen  lds
    s_add_u32 m0, s73, 12288
    s_add_u32 s70, s70, 65536
    buffer_load_dwordx4 v58, s[28:31], s70 offen  lds
    s_add_u32 m0, s73, 16384
    s_add_u32 s70, s70, 65536
    buffer_load_dwordx4 v58, s[28:31], s70 offen  lds
    s_add_u32 m0, s73, 20480
    s_add_u32 s70, s70, 65536
    buffer_load_dwordx4 v58, s[28:31], s70 offen  lds
    s_add_u32 s73, s73, s77
    s_add_u32 m0, s73, 24576
    s_nop 0
    buffer_load_dwordx4 v59, s[32:35], s71 offen  lds
    s_add_u32 m0, s73, 25600
    s_nop 0
    buffer_load_dwordx4 v59, s[32:35], s72 offen  lds
    s_add_u32 m0, s73, 32768
    s_add_u32 s71, s71, 262144
    buffer_load_dwordx4 v59, s[32:35], s71 offen  lds
    s_add_u32 m0, s73, 33792
    s_add_u32 s72, s72, 262144
    buffer_load_dwordx4 v59, s[32:35], s72 offen  lds
    s_add_u32 s64, s64, 40960
    s_cmp_eq_u32 s64, 163840
    s_cselect_b32 s64, 0, s64
    s_add_u32 s65, s65, 1
    s_setpc_b64 s[24:25]
F_IO:
    s_add_u32 s60, s65, s68
    s_and_b32 s60, s60, 7
    s_and_b32 s61, s65, 0x78
    s_lshl_b32 s61, s61, 1
    s_add_u32 s61, s61, s69
    s_add_u32 s60, s60, s61
    s_mul_i32 s70, s60, 24576
    s_add_u32 s70, s70, s66
    s_lshl_b32 s71, s60, 17
    s_lshl_b32 s61, s95, 18
    s_xor_b32 s71, s71, s61
    s_add_u32 s71, s71, s0
    s_add_u32 s73, s64, s77
    s_add_u32 m0, s73, 0
    s_xor_b32 s72, s71, 128
    buffer_load_dwordx4 v60, s[48:51], s70 offen sc1 lds
    s_add_u32 m0, s73, 4096
    s_add_u32 s70, s70, 4096
    buffer_load_dwordx4 v60, s[48:51], s70 offen sc1 lds
    s_add_u32 m0, s73, 8192
    s_add_u32 s70, s70, 4096
    buffer_load_dwordx4 v60, s[48:51], s70 offen sc1 lds
    s_add_u32 m0, s73, 12288
    s_add_u32 s70, s70, 4096
    buffer_load_dwordx4 v60, s[48:51], s70 offen sc1 lds
    s_add_u32 m0, s73, 16384
    s_add_u32 s70, s70, 4096
    buffer_load_dwordx4 v60, s[48:51], s70 offen sc1 lds
    s_add_u32 m0, s73, 20480
    s_add_u32 s70, s70, 4096
    buffer_load_dwordx4 v60, s[48:51], s70 offen sc1 lds
    s_add_u32 s73, s73, s77
    s_add_u32 m0, s73, 24576
    s_nop 0
    buffer_load_dwordx4 v61, s[36:39], s71 offen  lds
    s_add_u32 m0, s73, 25600
    s_nop 0
    buffer_load_dwordx4 v61, s[36:39], s72 offen  lds
    s_add_u32 m0, s73, 32768
    s_add_u32 s71, s71, 65536
    buffer_load_dwordx4 v61, s[36:39], s71 offen  lds
    s_add_u32 m0, s73, 33792
    s_add_u32 s72, s72, 65536
    buffer_load_dwordx4 v61, s[36:39], s72 offen  lds
    s_add_u32 s64, s64, 40960
    s_cmp_eq_u32 s64, 163840
    s_cselect_b32 s64, 0, s64
    s_add_u32 s65, s65, 1
    s_setpc_b64 s[24:25]
F_IT:
    s_add_u32 s60, s65, s68
    s_and_b32 s60, s60, 7
    s_and_b32 s61, s65, 8
    s_xor_b32 s61, s61, s69
    s_add_u32 s61, s61, 48
    s_add_u32 s60, s60, s61
    s_mul_i32 s70, s60, 24576
    s_add_u32 s70, s70, s66
    s_lshl_b32 s71, s60, 17
    s_lshl_b32 s61, s95, 18
    s_xor_b32 s71, s71, s61
    s_add_u32 s71, s71, s0
    s_add_u32 s73, s64, s77
    s_add_u32 m0, s73, 0
    s_xor_b32 s72, s71, 128
    buffer_load_dwordx4 v60, s[48:51], s70 offen sc1 lds
    s_add_u32 m0, s73, 4096
    s_add_u32 s70, s70, 4096
    buffer_load_dwordx4 v60, s[48:51], s70 offen sc1 lds
    s_add_u32 m0, s73, 8192
    s_add_u32 s70, s70, 4096
    buffer_load_dwordx4 v60, s[48:51], s70 offen sc1 lds
    s_add_u32 m0, s73, 12288
    s_add_u32 s70, s70, 4096
    buffer_load_dwordx4 v60, s[48:51], s70 offen sc1 lds
    s_add_u32 m0, s73, 16384
    s_add_u32 s70, s70, 4096
    buffer_load_dwordx4 v60, s[48:51], s70 offen sc1 lds
    s_add_u32 m0, s73, 20480
    s_add_u32 s70, s70, 4096
    buffer_load_dwordx4 v60, s[48:51], s70 offen sc1 lds
    s_add_u32 m0, s73, 24576
    s_nop 0
    buffer_load_dwordx4 v61, s[36:39], s71 offen  lds
    s_add_u32 m0, s73, 28672
    s_add_u32 s71, s71, 65536
    buffer_load_dwordx4 v61, s[36:39], s71 offen  lds
    s_add_u32 s64, s64, 40960
    s_cmp_eq_u32 s64, 163840
    s_cselect_b32 s64, 0, s64
    s_add_u32 s65, s65, 1
    s_setpc_b64 s[24:25]
F_IA0:
    s_add_u32 s73, s64, s77
    s_add_u32 s73, s73, s77
    s_add_u32 s70, s74, s75
    s_xor_b32 s71, s70, s79
    s_add_u32 m0, s73, 0
    s_add_u32 s75, s75, s78
    buffer_load_dwordx4 v62, s[40:43], s70 offen offset:0 nt lds
    s_add_u32 m0, s73, 896
    s_and_b32 s75, s75, 0x1ffff
    buffer_load_dwordx4 v62, s[40:43], s70 offen offset:128 nt lds
    s_add_u32 m0, s73, 8192
    s_nop 0
    buffer_load_dwordx4 v62, s[40:43], s71 offen offset:0 nt lds
    s_add_u32 m0, s73, 9088
    s_nop 0
    buffer_load_dwordx4 v62, s[40:43], s71 offen offset:128 nt lds
    s_add_u32 s70, s74, s75
    s_xor_b32 s71, s70, s79
    s_add_u32 m0, s73, 16384
    s_add_u32 s75, s75, s78
    buffer_load_dwordx4 v62, s[40:43], s70 offen offset:0 nt lds
    s_add_u32 m0, s73, 17280
    s_and_b32 s75, s75, 0x1ffff
    buffer_load_dwordx4 v62, s[40:43], s70 offen offset:128 nt lds
    s_add_u32 m0, s73, 24576
    s_nop 0
    buffer_load_dwordx4 v62, s[40:43], s71 offen offset:0 nt lds
    s_add_u32 m0, s73, 25472
    s_nop 0
    buffer_load_dwordx4 v62, s[40:43], s71 offen offset:128 nt lds
    s_add_u32 s64, s64, 40960
    s_cmp_eq_u32 s64, 163840
    s_cselect_b32 s64, 0, s64
    s_add_u32 s65, s65, 1
    s_setpc_b64 s[24:25]
F_IAM:
    s_add_u32 s73, s64, s77
    s_add_u32 s73, s73, s77
    s_add_u32 s70, s74, s76
    s_xor_b32 s71, s70, s79
    s_add_u32 m0, s73, 0
    s_add_u32 s76, s76, s78
    buffer_load_dwordx4 v63, s[44:47], s70 offen offset:0 nt lds
    s_add_u32 m0, s73, 896
    s_and_b32 s76, s76, 0x1ffff
    buffer_load_dwordx4 v63, s[44:47], s70 offen offset:128 nt lds
    s_add_u32 m0, s73, 8192
    s_nop 0
    buffer_load_dwordx4 v63, s[44:47], s71 offen offset:0 nt lds
    s_add_u32 m0, s73, 9088
    s_nop 0
    buffer_load_dwordx4 v63, s[44:47], s71 offen offset:128 nt lds
    s_add_u32 s70, s74, s75
    s_xor_b32 s71, s70, s79
    s_add_u32 m0, s73, 16384
    s_add_u32 s75, s75, s78
    buffer_load_dwordx4 v62, s[40:43], s70 offen offset:0 nt lds
    s_add_u32 m0, s73, 17280
    s_and_b32 s75, s75, 0x1ffff
    buffer_load_dwordx4 v62, s[40:43], s70 offen offset:128 nt lds
    s_add_u32 m0, s73, 24576
    s_nop 0
    buffer_load_dwordx4 v62, s[40:43], s71 offen offset:0 nt lds
    s_add_u32 m0, s73, 25472
    s_nop 0
    buffer_load_dwordx4 v62, s[40:43], s71 offen offset:128 nt lds
    s_add_u32 s64, s64, 40960
    s_cmp_eq_u32 s64, 163840
    s_cselect_b32 s64, 0, s64
    s_add_u32 s65, s65, 1
    s_setpc_b64 s[24:25]
F_IAL:
    s_add_u32 s73, s64, s77
    s_add_u32 s73, s73, s77
    s_add_u32 s70, s74, s76
    s_xor_b32 s71, s70, s79
    s_add_u32 m0, s73, 0
    s_add_u32 s76, s76, s78
    buffer_load_dwordx4 v63, s[44:47], s70 offen offset:0 nt lds
    s_add_u32 m0, s73, 896
    s_and_b32 s76, s76, 0x1ffff
    buffer_load_dwordx4 v63, s[44:47], s70 offen offset:128 nt lds
    s_add_u32 m0, s73, 8192
    s_nop 0
    buffer_load_dwordx4 v63, s[44:47], s71 offen offset:0 nt lds
    s_add_u32 m0, s73, 9088
    s_nop 0
    buffer_load_dwordx4 v63, s[44:47], s71 offen offset:128 nt lds
    s_add_u32 s70, s74, s76
    s_xor_b32 s71, s70, s79
    s_add_u32 m0, s73, 16384
    s_add_u32 s76, s76, s78
    buffer_load_dwordx4 v63, s[44:47], s70 offen offset:0 nt lds
    s_add_u32 m0, s73, 17280
    s_and_b32 s76, s76, 0x1ffff
    buffer_load_dwordx4 v63, s[44:47], s70 offen offset:128 nt lds
    s_add_u32 m0, s73, 24576
    s_nop 0
    buffer_load_dwordx4 v63, s[44:47], s71 offen offset:0 nt lds
    s_add_u32 m0, s73, 25472
    s_nop 0
    buffer_load_dwordx4 v63, s[44:47], s71 offen offset:128 nt lds
    s_add_u32 s64, s64, 40960
    s_cmp_eq_u32 s64, 163840
    s_cselect_b32 s64, 0, s64
    s_add_u32 s65, s65, 1
    s_setpc_b64 s[24:25]
F_SKIP:
    s_add_u32 s75, s75, s78
    s_and_b32 s75, s75, 0x1ffff
    s_add_u32 s76, s76, s78
    s_and_b32 s76, s76, 0x1ffff
    s_add_u32 s64, s64, 40960
    s_cmp_eq_u32 s64, 163840
    s_cselect_b32 s64, 0, s64
    s_add_u32 s65, s65, 1
    s_setpc_b64 s[24:25]
F_FPRE:
    s_cmp_lg_u32 s3, 0
    s_cbranch_scc1 F_RET1
    v_and_b32 v5, 15, v0
    v_lshlrev_b32 v5, 2, v5
    buffer_load_dword v4, v5, s[48:51], s19 offen sc1
F_RET1:
    s_setpc_b64 s[24:25]
F_FCHK:
    s_cmp_lg_u32 s3, 0
    s_cbranch_scc1 F_RET1
    s_mov_b32 s22, 0x40000
L_fchk:
    v_and_b32 v6, s21, v4
    v_cmp_ne_u32 vcc, 0, v6
    s_nop 1
    s_and_b32 s60, vcc_lo, s20
    s_cmp_eq_u32 s60, s20
    s_cbranch_scc1 F_RET1
    s_sub_u32 s22, s22, 1
    s_cmp_eq_u32 s22, 0
    s_cbranch_scc1 F_RET1
    s_sleep 2
    buffer_load_dword v4, v5, s[48:51], s19 offen sc1
    s_waitcnt vmcnt(0)
    s_branch L_fchk
F_SIG:
    s_cmp_lg_u32 s3, 0
    s_cbranch_scc1 F_RET1
    s_lshl_b32 s60, s5, 3
    s_add_u32 s60, s60, s7
    s_lshl_b32 s60, s60, 2
    v_mov_b32 v7, s60
    v_mov_b32 v6, s17
    s_mov_b64 exec, 1
    buffer_store_dword v6, v7, s[48:51], s19 offen sc1
    s_mov_b64 exec, -1
    s_setpc_b64 s[24:25]
F_GADR:
    v_bfe_u32 v1, v0, 3, 1
    s_mul_i32 s60, s3, 6
    v_add_u32 v1, s60, v1
    v_lshlrev_b32 v1, 10, v1
    v_and_b32 v52, 7, v0
    v_lshl_add_u32 v1, v52, 6, v1
    v_lshrrev_b32 v53, 4, v0
    v_lshrrev_b32 v52, 2, v0
    v_sub_u32 v52, 0, v52
    v_and_b32 v52, 3, v52
    v_xor_b32 v52, v52, v53
    v_lshl_add_u32 v1, v52, 4, v1
    v_lshlrev_b32 v2, 11, v53
    v_bfe_u32 v52, v0, 2, 2
    v_lshl_add_u32 v2, v52, 6, v2
    v_and_b32 v52, 1, v53
    v_lshl_add_u32 v2, v52, 5, v2
    v_and_b32 v52, 3, v0
    v_lshl_add_u32 v2, v52, 3, v2
    v_add_u32 v2, 24576, v2
    v_xor_b32 v3, 32, v2
    s_mov_b32 s12, 0
    s_setpc_b64 s[24:25]
F_TADR:
    v_bfe_u32 v1, v0, 3, 1
    s_mul_i32 s60, s3, 6
    v_add_u32 v1, s60, v1
    v_lshlrev_b32 v1, 10, v1
    v_and_b32 v52, 7, v0
    v_lshl_add_u32 v1, v52, 6, v1
    v_lshrrev_b32 v53, 4, v0
    v_lshrrev_b32 v52, 2, v0
    v_sub_u32 v52, 0, v52
    v_and_b32 v52, 3, v52
    v_xor_b32 v52, v52, v53
    v_lshl_add_u32 v1, v52, 4, v1
    v_lshlrev_b32 v2, 10, v53
    v_bfe_u32 v52, v0, 2, 2
    v_lshl_add_u32 v2, v52, 6, v2
    v_and_b32 v52, 1, v53
    v_lshl_add_u32 v2, v52, 5, v2
    v_and_b32 v52, 3, v0
    v_lshl_add_u32 v2, v52, 3, v2
    v_add_u32 v2, 24576, v2
    v_xor_b32 v3, 32, v2
    s_mov_b32 s12, 0
    s_setpc_b64 s[24:25]
F_GEMM:
    ds_read_b64_tr_b16 v[88:89], v2 offset:0
    ds_read_b64_tr_b16 v[90:91], v2 offset:256
    ds_read_b64_tr_b16 v[92:93], v2 offset:8192
    ds_read_b64_tr_b16 v[94:95], v2 offset:8448
    ds_read_b64_tr_b16 v[96:97], v3 offset:0
    ds_read_b128 v[64:67], v1 offset:0
    ds_read_b128 v[76:79], v1 offset:512
    ds_read_b64_tr_b16 v[98:99], v3 offset:256
    ds_read_b128 v[68:71], v1 offset:2048
    ds_read_b128 v[80:83], v1 offset:2560
    ds_read_b64_tr_b16 v[100:101], v3 offset:8192
    ds_read_b128 v[72:75], v1 offset:4096
    ds_read_b128 v[84:87], v1 offset:4608
    ds_read_b64_tr_b16 v[102:103], v3 offset:8448
    s_mov_b32 s63, 40960
    s_mov_b32 s62, 4294844416
    s_mov_b32 s13, 0
    s_waitcnt lgkmcnt(7)
    v_mfma_f32_16x16x32_bf16 v[112:115], v[88:91], v[64:67], 0
    ds_read_b64_tr_b16 v[104:105], v2 offset:512
    v_mfma_f32_16x16x32_bf16 v[112:115], v[92:95], v[76:79], v[112:115]
    ds_read_b64_tr_b16 v[106:107], v2 offset:768
    s_waitcnt lgkmcnt(6)
    v_mfma_f32_16x16x32_bf16 v[116:119], v[92:95], v[80:83], 0
    ds_read_b64_tr_b16 v[108:109], v2 offset:8704
    v_mfma_f32_16x16x32_bf16 v[116:119], v[88:91], v[68:71], v[116:119]
    ds_read_b64_tr_b16 v[110:111], v2 offset:8960
    s_waitcnt lgkmcnt(5)
    v_mfma_f32_16x16x32_bf16 v[120:123], v[88:91], v[72:75], 0
    s_add_u32 s12, s12, 1
    s_and_b32 s12, s12, 3
    v_mfma_f32_16x16x32_bf16 v[120:123], v[92:95], v[84:87], v[120:123]
    s_cselect_b32 s16, s63, s62
    s_add_u32 s13, s13, 1
    s_waitcnt lgkmcnt(4)
    v_mfma_f32_16x16x32_bf16 v[132:135], v[100:103], v[84:87], 0
    ds_read_b64_tr_b16 v[36:37], v3 offset:512
    v_mfma_f32_16x16x32_bf16 v[132:135], v[96:99], v[72:75], v[132:135]
    ds_read_b64_tr_b16 v[38:39], v3 offset:768
    v_mfma_f32_16x16x32_bf16 v[128:131], v[96:99], v[68:71], 0
    ds_read_b64_tr_b16 v[40:41], v3 offset:8704
    v_mfma_f32_16x16x32_bf16 v[128:131], v[100:103], v[80:83], v[128:131]
    ds_read_b64_tr_b16 v[42:43], v3 offset:8960
    v_pk_mov_b32 v[202:203], 0, 0
    v_mfma_f32_16x16x32_bf16 v[124:127], v[100:103], v[76:79], 0
    v_pk_mov_b32 v[206:207], 0, 0
    v_mfma_f32_16x16x32_bf16 v[124:127], v[96:99], v[64:67], v[124:127]
    v_pk_mov_b32 v[204:205], 0, 0
    s_waitcnt lgkmcnt(4)
    v_mfma_f32_16x16x32_bf16 v[136:139], v[104:107], v[64:67], 0
    ds_read_b64_tr_b16 v[88:89], v2 offset:1024
    v_mfma_f32_16x16x32_bf16 v[136:139], v[108:111], v[76:79], v[136:139]
    ds_read_b64_tr_b16 v[90:91], v2 offset:1280
    v_mfma_f32_16x16x32_bf16 v[140:143], v[108:111], v[80:83], 0
    ds_read_b64_tr_b16 v[92:93], v2 offset:9216
    v_mfma_f32_16x16x32_bf16 v[140:143], v[104:107], v[68:71], v[140:143]
    ds_read_b64_tr_b16 v[94:95], v2 offset:9472
    v_pk_mov_b32 v[196:197], 0, 0
    v_mfma_f32_16x16x32_bf16 v[144:147], v[104:107], v[72:75], 0
    v_pk_mov_b32 v[200:201], 0, 0
    v_mfma_f32_16x16x32_bf16 v[144:147], v[108:111], v[84:87], v[144:147]
    v_pk_mov_b32 v[198:199], 0, 0
    s_waitcnt lgkmcnt(4)
    v_mfma_f32_16x16x32_bf16 v[156:159], v[40:43], v[84:87], 0
    ds_read_b64_tr_b16 v[96:97], v3 offset:1024
    v_mfma_f32_16x16x32_bf16 v[156:159], v[36:39], v[72:75], v[156:159]
    ds_read_b64_tr_b16 v[98:99], v3 offset:1280
    v_mfma_f32_16x16x32_bf16 v[152:155], v[36:39], v[68:71], 0
    ds_read_b64_tr_b16 v[100:101], v3 offset:9216
    v_mfma_f32_16x16x32_bf16 v[152:155], v[40:43], v[80:83], v[152:155]
    ds_read_b64_tr_b16 v[102:103], v3 offset:9472
    v_pk_mov_b32 v[190:191], 0, 0
    v_mfma_f32_16x16x32_bf16 v[148:151], v[40:43], v[76:79], 0
    v_pk_mov_b32 v[194:195], 0, 0
    v_mfma_f32_16x16x32_bf16 v[148:151], v[36:39], v[64:67], v[148:151]
    v_pk_mov_b32 v[192:193], 0, 0
    s_waitcnt lgkmcnt(4)
    v_mfma_f32_16x16x32_bf16 v[160:163], v[88:91], v[64:67], 0
    ds_read_b64_tr_b16 v[104:105], v2 offset:1536
    v_mfma_f32_16x16x32_bf16 v[160:163], v[92:95], v[76:79], v[160:163]
    ds_read_b64_tr_b16 v[106:107], v2 offset:1792
    v_mfma_f32_16x16x32_bf16 v[164:167], v[92:95], v[80:83], 0
    ds_read_b64_tr_b16 v[108:109], v2 offset:9728
    v_mfma_f32_16x16x32_bf16 v[164:167], v[88:91], v[68:71], v[164:167]
    ds_read_b64_tr_b16 v[110:111], v2 offset:9984
    v_mfma_f32_16x16x32_bf16 v[168:171], v[88:91], v[72:75], 0
    v_pk_mov_b32 v[188:189], 0, 0
    v_mfma_f32_16x16x32_bf16 v[168:171], v[92:95], v[84:87], v[168:171]
    s_waitcnt lgkmcnt(4)
    v_mfma_f32_16x16x32_bf16 v[180:183], v[100:103], v[84:87], 0
    ds_read_b64_tr_b16 v[36:37], v3 offset:1536
    ds_read_b64_tr_b16 v[38:39], v3 offset:1792
    v_mfma_f32_16x16x32_bf16 v[180:183], v[96:99], v[72:75], v[180:183]
    ds_read_b64_tr_b16 v[40:41], v3 offset:9728
    ds_read_b64_tr_b16 v[42:43], v3 offset:9984
    v_mfma_f32_16x16x32_bf16 v[176:179], v[96:99], v[68:71], 0
    v_add_u32 v1, s16, v1
    v_mfma_f32_16x16x32_bf16 v[176:179], v[100:103], v[80:83], v[176:179]
    v_add_u32 v2, s16, v2
    v_mfma_f32_16x16x32_bf16 v[172:175], v[100:103], v[76:79], 0
    v_add_u32 v3, s16, v3
    v_mfma_f32_16x16x32_bf16 v[172:175], v[96:99], v[64:67], v[172:175]
    s_waitcnt lgkmcnt(4)
    v_mfma_f32_16x16x32_bf16 v[184:187], v[104:107], v[64:67], 0
    s_cmp_lg_u32 s13, s15
    v_mfma_f32_16x16x32_bf16 v[184:187], v[108:111], v[76:79], v[184:187]
    s_waitcnt lgkmcnt(0)
    s_cbranch_scc0 L_gs_30
L_gl_28:
    s_barrier
L_gb_29:
    v_mfma_f32_16x16x32_bf16 v[188:191], v[108:111], v[80:83], v[188:191]
    ds_read_b64_tr_b16 v[88:89], v2 offset:0
    v_mfma_f32_16x16x32_bf16 v[188:191], v[104:107], v[68:71], v[188:191]
    ds_read_b64_tr_b16 v[90:91], v2 offset:256
    v_mfma_f32_16x16x32_bf16 v[192:195], v[104:107], v[72:75], v[192:195]
    ds_read_b64_tr_b16 v[92:93], v2 offset:8192
    v_mfma_f32_16x16x32_bf16 v[192:195], v[108:111], v[84:87], v[192:195]
    ds_read_b64_tr_b16 v[94:95], v2 offset:8448
    v_mfma_f32_16x16x32_bf16 v[196:199], v[40:43], v[76:79], v[196:199]
    ds_read_b64_tr_b16 v[96:97], v3 offset:0
    v_mfma_f32_16x16x32_bf16 v[196:199], v[36:39], v[64:67], v[196:199]
    ds_read_b128 v[64:67], v1 offset:0
    ds_read_b128 v[76:79], v1 offset:512
    v_mfma_f32_16x16x32_bf16 v[200:203], v[36:39], v[68:71], v[200:203]
    ds_read_b64_tr_b16 v[98:99], v3 offset:256
    v_mfma_f32_16x16x32_bf16 v[200:203], v[40:43], v[80:83], v[200:203]
    ds_read_b128 v[68:71], v1 offset:2048
    ds_read_b128 v[80:83], v1 offset:2560
    v_mfma_f32_16x16x32_bf16 v[204:207], v[40:43], v[84:87], v[204:207]
    ds_read_b64_tr_b16 v[100:101], v3 offset:8192
    v_mfma_f32_16x16x32_bf16 v[204:207], v[36:39], v[72:75], v[204:207]
    ds_read_b128 v[72:75], v1 offset:4096
    ds_read_b128 v[84:87], v1 offset:4608
    ds_read_b64_tr_b16 v[102:103], v3 offset:8448
F_GEMM_P1:
    s_waitcnt lgkmcnt(7)
    v_mfma_f32_16x16x32_bf16 v[112:115], v[88:91], v[64:67], v[112:115]
    ds_read_b64_tr_b16 v[104:105], v2 offset:512
    v_mfma_f32_16x16x32_bf16 v[112:115], v[92:95], v[76:79], v[112:115]
    ds_read_b64_tr_b16 v[106:107], v2 offset:768
    s_waitcnt lgkmcnt(6)
    v_mfma_f32_16x16x32_bf16 v[116:119], v[92:95], v[80:83], v[116:119]
    ds_read_b64_tr_b16 v[108:109], v2 offset:8704
    v_mfma_f32_16x16x32_bf16 v[116:119], v[88:91], v[68:71], v[116:119]
    ds_read_b64_tr_b16 v[110:111], v2 offset:8960
    s_waitcnt lgkmcnt(5)
    v_mfma_f32_16x16x32_bf16 v[120:123], v[88:91], v[72:75], v[120:123]
    s_add_u32 s12, s12, 1
    s_and_b32 s12, s12, 3
    v_mfma_f32_16x16x32_bf16 v[120:123], v[92:95], v[84:87], v[120:123]
    s_cselect_b32 s16, s63, s62
    s_add_u32 s13, s13, 1
    s_waitcnt lgkmcnt(4)
    v_mfma_f32_16x16x32_bf16 v[132:135], v[100:103], v[84:87], v[132:135]
    ds_read_b64_tr_b16 v[36:37], v3 offset:512
    v_mfma_f32_16x16x32_bf16 v[132:135], v[96:99], v[72:75], v[132:135]
    ds_read_b64_tr_b16 v[38:39], v3 offset:768
    v_mfma_f32_16x16x32_bf16 v[128:131], v[96:99], v[68:71], v[128:131]
    ds_read_b64_tr_b16 v[40:41], v3 offset:8704
    v_mfma_f32_16x16x32_bf16 v[128:131], v[100:103], v[80:83], v[128:131]
    ds_read_b64_tr_b16 v[42:43], v3 offset:8960
    v_mfma_f32_16x16x32_bf16 v[124:127], v[100:103], v[76:79], v[124:127]
    v_mfma_f32_16x16x32_bf16 v[124:127], v[96:99], v[64:67], v[124:127]
    s_waitcnt lgkmcnt(4)
    v_mfma_f32_16x16x32_bf16 v[136:139], v[104:107], v[64:67], v[136:139]
    ds_read_b64_tr_b16 v[88:89], v2 offset:1024
    v_mfma_f32_16x16x32_bf16 v[136:139], v[108:111], v[76:79], v[136:139]
    ds_read_b64_tr_b16 v[90:91], v2 offset:1280
    v_mfma_f32_16x16x32_bf16 v[140:143], v[108:111], v[80:83], v[140:143]
    ds_read_b64_tr_b16 v[92:93], v2 offset:9216
    v_mfma_f32_16x16x32_bf16 v[140:143], v[104:107], v[68:71], v[140:143]
    ds_read_b64_tr_b16 v[94:95], v2 offset:9472
    v_mfma_f32_16x16x32_bf16 v[144:147], v[104:107], v[72:75], v[144:147]
    v_mfma_f32_16x16x32_bf16 v[144:147], v[108:111], v[84:87], v[144:147]
    s_waitcnt lgkmcnt(4)
    v_mfma_f32_16x16x32_bf16 v[156:159], v[40:43], v[84:87], v[156:159]
    ds_read_b64_tr_b16 v[96:97], v3 offset:1024
    v_mfma_f32_16x16x32_bf16 v[156:159], v[36:39], v[72:75], v[156:159]
    ds_read_b64_tr_b16 v[98:99], v3 offset:1280
    v_mfma_f32_16x16x32_bf16 v[152:155], v[36:39], v[68:71], v[152:155]
    ds_read_b64_tr_b16 v[100:101], v3 offset:9216
    v_mfma_f32_16x16x32_bf16 v[152:155], v[40:43], v[80:83], v[152:155]
    ds_read_b64_tr_b16 v[102:103], v3 offset:9472
    v_mfma_f32_16x16x32_bf16 v[148:151], v[40:43], v[76:79], v[148:151]
    v_mfma_f32_16x16x32_bf16 v[148:151], v[36:39], v[64:67], v[148:151]
    s_waitcnt lgkmcnt(4)
    v_mfma_f32_16x16x32_bf16 v[160:163], v[88:91], v[64:67], v[160:163]
    ds_read_b64_tr_b16 v[104:105], v2 offset:1536
    v_mfma_f32_16x16x32_bf16 v[160:163], v[92:95], v[76:79], v[160:163]
    ds_read_b64_tr_b16 v[106:107], v2 offset:1792
    v_mfma_f32_16x16x32_bf16 v[164:167], v[92:95], v[80:83], v[164:167]
    ds_read_b64_tr_b16 v[108:109], v2 offset:9728
    v_mfma_f32_16x16x32_bf16 v[164:167], v[88:91], v[68:71], v[164:167]
    ds_read_b64_tr_b16 v[110:111], v2 offset:9984
    v_mfma_f32_16x16x32_bf16 v[168:171], v[88:91], v[72:75], v[168:171]
    v_mfma_f32_16x16x32_bf16 v[168:171], v[92:95], v[84:87], v[168:171]
    s_waitcnt lgkmcnt(4)
    v_mfma_f32_16x16x32_bf16 v[180:183], v[100:103], v[84:87], v[180:183]
    ds_read_b64_tr_b16 v[36:37], v3 offset:1536
    ds_read_b64_tr_b16 v[38:39], v3 offset:1792
    v_mfma_f32_16x16x32_bf16 v[180:183], v[96:99], v[72:75], v[180:183]
    ds_read_b64_tr_b16 v[40:41], v3 offset:9728
    ds_read_b64_tr_b16 v[42:43], v3 offset:9984
    v_mfma_f32_16x16x32_bf16 v[176:179], v[96:99], v[68:71], v[176:179]
    v_add_u32 v1, s16, v1
    v_mfma_f32_16x16x32_bf16 v[176:179], v[100:103], v[80:83], v[176:179]
    v_add_u32 v2, s16, v2
    v_mfma_f32_16x16x32_bf16 v[172:175], v[100:103], v[76:79], v[172:175]
    v_add_u32 v3, s16, v3
    v_mfma_f32_16x16x32_bf16 v[172:175], v[96:99], v[64:67], v[172:175]
    s_waitcnt lgkmcnt(4)
    v_mfma_f32_16x16x32_bf16 v[184:187], v[104:107], v[64:67], v[184:187]
    s_cmp_lg_u32 s13, s15
    v_mfma_f32_16x16x32_bf16 v[184:187], v[108:111], v[76:79], v[184:187]
    s_waitcnt lgkmcnt(0)
    s_cbranch_scc1 L_gl_28
L_gs_30:
    s_cmp_eq_u32 s13, s14
    s_cbranch_scc1 L_gf_31
    s_cmp_lt_u32 s17, 62
    s_cbranch_scc1 L_hz_34
    s_barrier
    s_add_u32 s71, s70, 24576
    buffer_store_dwordx4 v[208:211], v7, s[48:51], s70 offen offset:0 sc1
    buffer_store_dwordx4 v[212:215], v7, s[48:51], s70 offen offset:512 sc1
    buffer_store_dwordx4 v[216:219], v7, s[48:51], s71 offen offset:0 sc1
    buffer_store_dwordx4 v[220:223], v7, s[48:51], s71 offen offset:512 sc1
    s_add_u32 s70, s70, 2048
L_hn_35:
    s_add_u32 s71, s70, 24576
    buffer_store_dwordx4 v[224:227], v7, s[48:51], s70 offen offset:0 sc1
    buffer_store_dwordx4 v[228:231], v7, s[48:51], s70 offen offset:512 sc1
    buffer_store_dwordx4 v[232:235], v7, s[48:51], s71 offen offset:0 sc1
    buffer_store_dwordx4 v[236:239], v7, s[48:51], s71 offen offset:512 sc1
    s_add_u32 s70, s70, 2048
L_hn_36:
    s_add_u32 s71, s70, 24576
    buffer_store_dwordx4 v[240:243], v7, s[48:51], s70 offen offset:0 sc1
    buffer_store_dwordx4 v[244:247], v7, s[48:51], s70 offen offset:512 sc1
    buffer_store_dwordx4 v[248:251], v7, s[48:51], s71 offen offset:0 sc1
    buffer_store_dwordx4 v[252:255], v7, s[48:51], s71 offen offset:512 sc1
L_hn_37:
    s_mov_b32 s17, 1
    s_branch L_hk_32
L_hz_34:
    s_waitcnt vmcnt(10)
    s_cmp_eq_u32 s13, 1
    s_cbranch_scc1 L_hy_33
    s_waitcnt vmcnt(0)
L_hy_33:
    s_barrier
    s_cmp_eq_u32 s17, 0
    s_cbranch_scc1 L_hk_32
    s_call_b64 s[24:25], F_SIG
L_hk_32:
    s_mov_b32 s15, s1
    s_mov_b32 s1, s14
    s_branch L_gb_29
F_GEMMC:
    ds_read_b64_tr_b16 v[88:89], v2 offset:0
    ds_read_b64_tr_b16 v[90:91], v2 offset:256
    ds_read_b64_tr_b16 v[92:93], v2 offset:8192
    ds_read_b64_tr_b16 v[94:95], v2 offset:8448
    ds_read_b64_tr_b16 v[96:97], v3 offset:0
    ds_read_b128 v[64:67], v1 offset:0
    ds_read_b128 v[76:79], v1 offset:512
    ds_read_b64_tr_b16 v[98:99], v3 offset:256
    ds_read_b128 v[68:71], v1 offset:2048
    ds_read_b128 v[80:83], v1 offset:2560
    ds_read_b64_tr_b16 v[100:101], v3 offset:8192
    ds_read_b128 v[72:75], v1 offset:4096
    ds_read_b128 v[84:87], v1 offset:4608
    ds_read_b64_tr_b16 v[102:103], v3 offset:8448
    s_mov_b32 s63, 40960
    s_mov_b32 s62, 4294844416
    s_mov_b32 s13, 0
    s_branch F_GEMM_P1
L_gf_31:
    v_mfma_f32_16x16x32_bf16 v[188:191], v[108:111], v[80:83], v[188:191]
    v_mfma_f32_16x16x32_bf16 v[188:191], v[104:107], v[68:71], v[188:191]
    v_mfma_f32_16x16x32_bf16 v[192:195], v[104:107], v[72:75], v[192:195]
    v_mfma_f32_16x16x32_bf16 v[192:195], v[108:111], v[84:87], v[192:195]
    v_mfma_f32_16x16x32_bf16 v[196:199], v[40:43], v[76:79], v[196:199]
    v_mfma_f32_16x16x32_bf16 v[196:199], v[36:39], v[64:67], v[196:199]
    v_mfma_f32_16x16x32_bf16 v[200:203], v[36:39], v[68:71], v[200:203]
    v_mfma_f32_16x16x32_bf16 v[200:203], v[40:43], v[80:83], v[200:203]
    v_mfma_f32_16x16x32_bf16 v[204:207], v[40:43], v[84:87], v[204:207]
    v_mfma_f32_16x16x32_bf16 v[204:207], v[36:39], v[72:75], v[204:207]
    s_nop 6
    s_setpc_b64 s[26:27]
F_PACKQ:
    v_mov_b32 v52, 0x3e0293ee
    v_mov_b32 v53, 0x3e0293ee
    v_pk_mul_f32 v[112:113], v[112:113], v[52:53]
    v_pk_mul_f32 v[114:115], v[114:115], v[52:53]
    v_pk_mul_f32 v[124:125], v[124:125], v[52:53]
    v_pk_mul_f32 v[126:127], v[126:127], v[52:53]
    v_cvt_pk_bf16_f32 v208, v112, v113
    v_cvt_pk_bf16_f32 v210, v124, v125
    v_cvt_pk_bf16_f32 v209, v114, v115
    v_cvt_pk_bf16_f32 v211, v126, v127
    v_pk_mul_f32 v[136:137], v[136:137], v[52:53]
    v_pk_mul_f32 v[138:139], v[138:139], v[52:53]
    v_pk_mul_f32 v[148:149], v[148:149], v[52:53]
    v_pk_mul_f32 v[150:151], v[150:151], v[52:53]
    v_cvt_pk_bf16_f32 v212, v136, v137
    v_cvt_pk_bf16_f32 v214, v148, v149
    v_cvt_pk_bf16_f32 v213, v138, v139
    v_cvt_pk_bf16_f32 v215, v150, v151
    v_permlane16_swap_b32 v208, v210
    v_permlane16_swap_b32 v209, v211
    v_pk_mul_f32 v[160:161], v[160:161], v[52:53]
    v_pk_mul_f32 v[162:163], v[162:163], v[52:53]
    v_pk_mul_f32 v[172:173], v[172:173], v[52:53]
    v_pk_mul_f32 v[174:175], v[174:175], v[52:53]
    v_cvt_pk_bf16_f32 v216, v160, v161
    v_cvt_pk_bf16_f32 v218, v172, v173
    v_cvt_pk_bf16_f32 v217, v162, v163
    v_cvt_pk_bf16_f32 v219, v174, v175
    v_permlane16_swap_b32 v212, v214
    v_permlane16_swap_b32 v213, v215
    v_pk_mul_f32 v[184:185], v[184:185], v[52:53]
    v_pk_mul_f32 v[186:187], v[186:187], v[52:53]
    v_pk_mul_f32 v[196:197], v[196:197], v[52:53]
    v_pk_mul_f32 v[198:199], v[198:199], v[52:53]
    v_cvt_pk_bf16_f32 v220, v184, v185
    v_cvt_pk_bf16_f32 v222, v196, v197
    v_cvt_pk_bf16_f32 v221, v186, v187
    v_cvt_pk_bf16_f32 v223, v198, v199
    v_permlane16_swap_b32 v216, v218
    v_permlane16_swap_b32 v217, v219
    s_nop 0
    v_permlane16_swap_b32 v220, v222
    v_permlane16_swap_b32 v221, v223
    v_pk_mul_f32 v[116:117], v[116:117], v[52:53]
    v_pk_mul_f32 v[118:119], v[118:119], v[52:53]
    v_pk_mul_f32 v[128:129], v[128:129], v[52:53]
    v_pk_mul_f32 v[130:131], v[130:131], v[52:53]
    v_cvt_pk_bf16_f32 v224, v116, v117
    v_cvt_pk_bf16_f32 v226, v128, v129
    v_cvt_pk_bf16_f32 v225, v118, v119
    v_cvt_pk_bf16_f32 v227, v130, v131
    v_pk_mul_f32 v[140:141], v[140:141], v[52:53]
    v_pk_mul_f32 v[142:143], v[142:143], v[52:53]
    v_pk_mul_f32 v[152:153], v[152:153], v[52:53]
    v_pk_mul_f32 v[154:155], v[154:155], v[52:53]
    v_cvt_pk_bf16_f32 v228, v140, v141
    v_cvt_pk_bf16_f32 v230, v152, v153
    v_cvt_pk_bf16_f32 v229, v142, v143
    v_cvt_pk_bf16_f32 v231, v154, v155
    v_permlane16_swap_b32 v224, v226
    v_permlane16_swap_b32 v225, v227
    v_pk_mul_f32 v[164:165], v[164:165], v[52:53]
    v_pk_mul_f32 v[166:167], v[166:167], v[52:53]
    v_pk_mul_f32 v[176:177], v[176:177], v[52:53]
    v_pk_mul_f32 v[178:179], v[178:179], v[52:53]
    v_cvt_pk_bf16_f32 v232, v164, v165
    v_cvt_pk_bf16_f32 v234, v176, v177
    v_cvt_pk_bf16_f32 v233, v166, v167
    v_cvt_pk_bf16_f32 v235, v178, v179
    v_permlane16_swap_b32 v228, v230
    v_permlane16_swap_b32 v229, v231
    v_pk_mul_f32 v[188:189], v[188:189], v[52:53]
    v_pk_mul_f32 v[190:191], v[190:191], v[52:53]
    v_pk_mul_f32 v[200:201], v[200:201], v[52:53]
    v_pk_mul_f32 v[202:203], v[202:203], v[52:53]
    v_cvt_pk_bf16_f32 v236, v188, v189
    v_cvt_pk_bf16_f32 v238, v200, v201
    v_cvt_pk_bf16_f32 v237, v190, v191
    v_cvt_pk_bf16_f32 v239, v202, v203
    v_permlane16_swap_b32 v232, v234
    v_permlane16_swap_b32 v233, v235
    s_nop 0
    v_permlane16_swap_b32 v236, v238
    v_permlane16_swap_b32 v237, v239
    v_pk_mul_f32 v[120:121], v[120:121], v[52:53]
    v_pk_mul_f32 v[122:123], v[122:123], v[52:53]
    v_pk_mul_f32 v[132:133], v[132:133], v[52:53]
    v_pk_mul_f32 v[134:135], v[134:135], v[52:53]
    v_cvt_pk_bf16_f32 v240, v120, v121
    v_cvt_pk_bf16_f32 v242, v132, v133
    v_cvt_pk_bf16_f32 v241, v122, v123
    v_cvt_pk_bf16_f32 v243, v134, v135
    v_pk_mul_f32 v[144:145], v[144:145], v[52:53]
    v_pk_mul_f32 v[146:147], v[146:147], v[52:53]
    v_pk_mul_f32 v[156:157], v[156:157], v[52:53]
    v_pk_mul_f32 v[158:159], v[158:159], v[52:53]
    v_cvt_pk_bf16_f32 v244, v144, v145
    v_cvt_pk_bf16_f32 v246, v156, v157
    v_cvt_pk_bf16_f32 v245, v146, v147
    v_cvt_pk_bf16_f32 v247, v158, v159
    v_permlane16_swap_b32 v240, v242
    v_permlane16_swap_b32 v241, v243
    v_pk_mul_f32 v[168:169], v[168:169], v[52:53]
    v_pk_mul_f32 v[170:171], v[170:171], v[52:53]
    v_pk_mul_f32 v[180:181], v[180:181], v[52:53]
    v_pk_mul_f32 v[182:183], v[182:183], v[52:53]
    v_cvt_pk_bf16_f32 v248, v168, v169
    v_cvt_pk_bf16_f32 v250, v180, v181
    v_cvt_pk_bf16_f32 v249, v170, v171
    v_cvt_pk_bf16_f32 v251, v182, v183
    v_permlane16_swap_b32 v244, v246
    v_permlane16_swap_b32 v245, v247
    v_pk_mul_f32 v[192:193], v[192:193], v[52:53]
    v_pk_mul_f32 v[194:195], v[194:195], v[52:53]
    v_pk_mul_f32 v[204:205], v[204:205], v[52:53]
    v_pk_mul_f32 v[206:207], v[206:207], v[52:53]
    v_cvt_pk_bf16_f32 v252, v192, v193
    v_cvt_pk_bf16_f32 v254, v204, v205
    v_cvt_pk_bf16_f32 v253, v194, v195
    v_cvt_pk_bf16_f32 v255, v206, v207
    v_permlane16_swap_b32 v248, v250
    v_permlane16_swap_b32 v249, v251
    s_nop 0
    v_permlane16_swap_b32 v252, v254
    v_permlane16_swap_b32 v253, v255
    s_setpc_b64 s[24:25]
F_EP0:
    v_bfe_u32 v1, v0, 3, 1
    s_mul_i32 s60, s3, 6
    v_add_u32 v1, s60, v1
    v_lshlrev_b32 v1, 10, v1
    v_and_b32 v52, 7, v0
    v_lshl_add_u32 v1, v52, 6, v1
    v_lshrrev_b32 v53, 5, v0
    v_bfe_u32 v52, v0, 4, 1
    v_lshl_or_b32 v53, v52, 1, v53
    v_lshrrev_b32 v52, 2, v0
    v_sub_u32 v52, 0, v52
    v_and_b32 v52, 3, v52
    v_xor_b32 v52, v52, v53
    v_lshl_add_u32 v1, v52, 4, v1
    s_lshl_b32 s60, s18, 1
    s_add_u32 s60, s60, s5
    s_lshl_b32 s60, s60, 3
    s_add_u32 s60, s60, s7
    s_lshl_b32 s61, s9, 5
    s_add_u32 s60, s60, s61
    s_mul_i32 s12, s60, 49152
    s_add_u32 s12, s12, 33554432
    v_rcp_f32 v52, v24
    s_add_u32 s16, s12, 24576
    v_mov_b32 v53, v52
    v_pk_mul_f32 v[112:113], v[112:113], v[52:53]
    v_pk_mul_f32 v[114:115], v[114:115], v[52:53]
    v_pk_mul_f32 v[124:125], v[124:125], v[52:53]
    v_pk_mul_f32 v[126:127], v[126:127], v[52:53]
    v_cvt_pk_bf16_f32 v208, v112, v113
    v_cvt_pk_bf16_f32 v210, v124, v125
    v_cvt_pk_bf16_f32 v209, v114, v115
    v_cvt_pk_bf16_f32 v211, v126, v127
    s_nop 0
    v_permlane16_swap_b32 v208, v210
    v_permlane16_swap_b32 v209, v211
    buffer_store_dwordx4 v[208:211], v1, s[48:51], s12 offen offset:0 sc1
    s_setpc_b64 s[24:25]
F_EP1:
    v_pk_mul_f32 v[136:137], v[136:137], v[52:53]
    v_pk_mul_f32 v[138:139], v[138:139], v[52:53]
    v_pk_mul_f32 v[148:149], v[148:149], v[52:53]
    v_pk_mul_f32 v[150:151], v[150:151], v[52:53]
    v_cvt_pk_bf16_f32 v212, v136, v137
    v_cvt_pk_bf16_f32 v214, v148, v149
    v_cvt_pk_bf16_f32 v213, v138, v139
    v_cvt_pk_bf16_f32 v215, v150, v151
    s_nop 0
    v_permlane16_swap_b32 v212, v214
    v_permlane16_swap_b32 v213, v215
    buffer_store_dwordx4 v[212:215], v1, s[48:51], s12 offen offset:512 sc1
    s_setpc_b64 s[24:25]
F_EP2:
    v_pk_mul_f32 v[160:161], v[160:161], v[52:53]
    v_pk_mul_f32 v[162:163], v[162:163], v[52:53]
    v_pk_mul_f32 v[172:173], v[172:173], v[52:53]
    v_pk_mul_f32 v[174:175], v[174:175], v[52:53]
    v_cvt_pk_bf16_f32 v216, v160, v161
    v_cvt_pk_bf16_f32 v218, v172, v173
    v_cvt_pk_bf16_f32 v217, v162, v163
    v_cvt_pk_bf16_f32 v219, v174, v175
    s_nop 0
    v_permlane16_swap_b32 v216, v218
    v_permlane16_swap_b32 v217, v219
    buffer_store_dwordx4 v[216:219], v1, s[48:51], s16 offen offset:0 sc1
    s_setpc_b64 s[24:25]
F_EP3:
    v_pk_mul_f32 v[184:185], v[184:185], v[52:53]
    v_pk_mul_f32 v[186:187], v[186:187], v[52:53]
    v_pk_mul_f32 v[196:197], v[196:197], v[52:53]
    v_pk_mul_f32 v[198:199], v[198:199], v[52:53]
    v_cvt_pk_bf16_f32 v220, v184, v185
    v_cvt_pk_bf16_f32 v222, v196, v197
    v_cvt_pk_bf16_f32 v221, v186, v187
    v_cvt_pk_bf16_f32 v223, v198, v199
    s_nop 0
    v_permlane16_swap_b32 v220, v222
    v_permlane16_swap_b32 v221, v223
    buffer_store_dwordx4 v[220:223], v1, s[48:51], s16 offen offset:512 sc1
    s_add_u32 s12, s12, 2048
    s_setpc_b64 s[24:25]
F_EP4:
    v_rcp_f32 v52, v28
    s_add_u32 s16, s12, 24576
    v_mov_b32 v53, v52
    v_pk_mul_f32 v[116:117], v[116:117], v[52:53]
    v_pk_mul_f32 v[118:119], v[118:119], v[52:53]
    v_pk_mul_f32 v[128:129], v[128:129], v[52:53]
    v_pk_mul_f32 v[130:131], v[130:131], v[52:53]
    v_cvt_pk_bf16_f32 v224, v116, v117
    v_cvt_pk_bf16_f32 v226, v128, v129
    v_cvt_pk_bf16_f32 v225, v118, v119
    v_cvt_pk_bf16_f32 v227, v130, v131
    s_nop 0
    v_permlane16_swap_b32 v224, v226
    v_permlane16_swap_b32 v225, v227
    buffer_store_dwordx4 v[224:227], v1, s[48:51], s12 offen offset:0 sc1
    s_setpc_b64 s[24:25]
F_EP5:
    v_pk_mul_f32 v[140:141], v[140:141], v[52:53]
    v_pk_mul_f32 v[142:143], v[142:143], v[52:53]
    v_pk_mul_f32 v[152:153], v[152:153], v[52:53]
    v_pk_mul_f32 v[154:155], v[154:155], v[52:53]
    v_cvt_pk_bf16_f32 v228, v140, v141
    v_cvt_pk_bf16_f32 v230, v152, v153
    v_cvt_pk_bf16_f32 v229, v142, v143
    v_cvt_pk_bf16_f32 v231, v154, v155
    s_nop 0
    v_permlane16_swap_b32 v228, v230
    v_permlane16_swap_b32 v229, v231
    buffer_store_dwordx4 v[228:231], v1, s[48:51], s12 offen offset:512 sc1
    s_setpc_b64 s[24:25]
F_EP6:
    v_pk_mul_f32 v[164:165], v[164:165], v[52:53]
    v_pk_mul_f32 v[166:167], v[166:167], v[52:53]
    v_pk_mul_f32 v[176:177], v[176:177], v[52:53]
    v_pk_mul_f32 v[178:179], v[178:179], v[52:53]
    v_cvt_pk_bf16_f32 v232, v164, v165
    v_cvt_pk_bf16_f32 v234, v176, v177
    v_cvt_pk_bf16_f32 v233, v166, v167
    v_cvt_pk_bf16_f32 v235, v178, v179
    s_nop 0
    v_permlane16_swap_b32 v232, v234
    v_permlane16_swap_b32 v233, v235
    buffer_store_dwordx4 v[232:235], v1, s[48:51], s16 offen offset:0 sc1
    s_setpc_b64 s[24:25]
F_EP7:
    v_pk_mul_f32 v[188:189], v[188:189], v[52:53]
    v_pk_mul_f32 v[190:191], v[190:191], v[52:53]
    v_pk_mul_f32 v[200:201], v[200:201], v[52:53]
    v_pk_mul_f32 v[202:203], v[202:203], v[52:53]
    v_cvt_pk_bf16_f32 v236, v188, v189
    v_cvt_pk_bf16_f32 v238, v200, v201
    v_cvt_pk_bf16_f32 v237, v190, v191
    v_cvt_pk_bf16_f32 v239, v202, v203
    s_nop 0
    v_permlane16_swap_b32 v236, v238
    v_permlane16_swap_b32 v237, v239
    buffer_store_dwordx4 v[236:239], v1, s[48:51], s16 offen offset:512 sc1
    s_add_u32 s12, s12, 2048
    s_setpc_b64 s[24:25]
F_EP8:
    v_rcp_f32 v52, v32
    s_add_u32 s16, s12, 24576
    v_mov_b32 v53, v52
    v_pk_mul_f32 v[120:121], v[120:121], v[52:53]
    v_pk_mul_f32 v[122:123], v[122:123], v[52:53]
    v_pk_mul_f32 v[132:133], v[132:133], v[52:53]
    v_pk_mul_f32 v[134:135], v[134:135], v[52:53]
    v_cvt_pk_bf16_f32 v240, v120, v121
    v_cvt_pk_bf16_f32 v242, v132, v133
    v_cvt_pk_bf16_f32 v241, v122, v123
    v_cvt_pk_bf16_f32 v243, v134, v135
    s_nop 0
    v_permlane16_swap_b32 v240, v242
    v_permlane16_swap_b32 v241, v243
    buffer_store_dwordx4 v[240:243], v1, s[48:51], s12 offen offset:0 sc1
    s_setpc_b64 s[24:25]
F_EP9:
    v_pk_mul_f32 v[144:145], v[144:145], v[52:53]
    v_pk_mul_f32 v[146:147], v[146:147], v[52:53]
    v_pk_mul_f32 v[156:157], v[156:157], v[52:53]
    v_pk_mul_f32 v[158:159], v[158:159], v[52:53]
    v_cvt_pk_bf16_f32 v244, v144, v145
    v_cvt_pk_bf16_f32 v246, v156, v157
    v_cvt_pk_bf16_f32 v245, v146, v147
    v_cvt_pk_bf16_f32 v247, v158, v159
    s_nop 0
    v_permlane16_swap_b32 v244, v246
    v_permlane16_swap_b32 v245, v247
    buffer_store_dwordx4 v[244:247], v1, s[48:51], s12 offen offset:512 sc1
    s_setpc_b64 s[24:25]
F_EP10:
    v_pk_mul_f32 v[168:169], v[168:169], v[52:53]
    v_pk_mul_f32 v[170:171], v[170:171], v[52:53]
    v_pk_mul_f32 v[180:181], v[180:181], v[52:53]
    v_pk_mul_f32 v[182:183], v[182:183], v[52:53]
    v_cvt_pk_bf16_f32 v248, v168, v169
    v_cvt_pk_bf16_f32 v250, v180, v181
    v_cvt_pk_bf16_f32 v249, v170, v171
    v_cvt_pk_bf16_f32 v251, v182, v183
    s_nop 0
    v_permlane16_swap_b32 v248, v250
    v_permlane16_swap_b32 v249, v251
    buffer_store_dwordx4 v[248:251], v1, s[48:51], s16 offen offset:0 sc1
    s_setpc_b64 s[24:25]
F_EP11:
    v_pk_mul_f32 v[192:193], v[192:193], v[52:53]
    v_pk_mul_f32 v[194:195], v[194:195], v[52:53]
    v_pk_mul_f32 v[204:205], v[204:205], v[52:53]
    v_pk_mul_f32 v[206:207], v[206:207], v[52:53]
    v_cvt_pk_bf16_f32 v252, v192, v193
    v_cvt_pk_bf16_f32 v254, v204, v205
    v_cvt_pk_bf16_f32 v253, v194, v195
    v_cvt_pk_bf16_f32 v255, v206, v207
    s_nop 0
    v_permlane16_swap_b32 v252, v254
    v_permlane16_swap_b32 v253, v255
    buffer_store_dwordx4 v[252:255], v1, s[48:51], s16 offen offset:512 sc1
    s_add_u32 s12, s12, 2048
    s_setpc_b64 s[24:25]
F_EPACK:
    v_rcp_f32 v52, v24
    s_nop 0
    v_mov_b32 v53, v52
    v_pk_mul_f32 v[112:113], v[112:113], v[52:53]
    v_pk_mul_f32 v[114:115], v[114:115], v[52:53]
    v_pk_mul_f32 v[124:125], v[124:125], v[52:53]
    v_pk_mul_f32 v[126:127], v[126:127], v[52:53]
    v_cvt_pk_bf16_f32 v208, v112, v113
    v_cvt_pk_bf16_f32 v210, v124, v125
    v_cvt_pk_bf16_f32 v209, v114, v115
    v_cvt_pk_bf16_f32 v211, v126, v127
    v_pk_mul_f32 v[136:137], v[136:137], v[52:53]
    v_pk_mul_f32 v[138:139], v[138:139], v[52:53]
    v_pk_mul_f32 v[148:149], v[148:149], v[52:53]
    v_pk_mul_f32 v[150:151], v[150:151], v[52:53]
    v_cvt_pk_bf16_f32 v212, v136, v137
    v_cvt_pk_bf16_f32 v214, v148, v149
    v_cvt_pk_bf16_f32 v213, v138, v139
    v_cvt_pk_bf16_f32 v215, v150, v151
    v_permlane16_swap_b32 v208, v210
    v_permlane16_swap_b32 v209, v211
    v_pk_mul_f32 v[160:161], v[160:161], v[52:53]
    v_pk_mul_f32 v[162:163], v[162:163], v[52:53]
    v_pk_mul_f32 v[172:173], v[172:173], v[52:53]
    v_pk_mul_f32 v[174:175], v[174:175], v[52:53]
    v_cvt_pk_bf16_f32 v216, v160, v161
    v_cvt_pk_bf16_f32 v218, v172, v173
    v_cvt_pk_bf16_f32 v217, v162, v163
    v_cvt_pk_bf16_f32 v219, v174, v175
    v_permlane16_swap_b32 v212, v214
    v_permlane16_swap_b32 v213, v215
    v_pk_mul_f32 v[184:185], v[184:185], v[52:53]
    v_pk_mul_f32 v[186:187], v[186:187], v[52:53]
    v_pk_mul_f32 v[196:197], v[196:197], v[52:53]
    v_pk_mul_f32 v[198:199], v[198:199], v[52:53]
    v_cvt_pk_bf16_f32 v220, v184, v185
    v_cvt_pk_bf16_f32 v222, v196, v197
    v_cvt_pk_bf16_f32 v221, v186, v187
    v_cvt_pk_bf16_f32 v223, v198, v199
    v_permlane16_swap_b32 v216, v218
    v_permlane16_swap_b32 v217, v219
    s_nop 0
    v_permlane16_swap_b32 v220, v222
    v_permlane16_swap_b32 v221, v223
    v_rcp_f32 v52, v28
    s_nop 0
    v_mov_b32 v53, v52
    v_pk_mul_f32 v[116:117], v[116:117], v[52:53]
    v_pk_mul_f32 v[118:119], v[118:119], v[52:53]
    v_pk_mul_f32 v[128:129], v[128:129], v[52:53]
    v_pk_mul_f32 v[130:131], v[130:131], v[52:53]
    v_cvt_pk_bf16_f32 v224, v116, v117
    v_cvt_pk_bf16_f32 v226, v128, v129
    v_cvt_pk_bf16_f32 v225, v118, v119
    v_cvt_pk_bf16_f32 v227, v130, v131
    v_pk_mul_f32 v[140:141], v[140:141], v[52:53]
    v_pk_mul_f32 v[142:143], v[142:143], v[52:53]
    v_pk_mul_f32 v[152:153], v[152:153], v[52:53]
    v_pk_mul_f32 v[154:155], v[154:155], v[52:53]
    v_cvt_pk_bf16_f32 v228, v140, v141
    v_cvt_pk_bf16_f32 v230, v152, v153
    v_cvt_pk_bf16_f32 v229, v142, v143
    v_cvt_pk_bf16_f32 v231, v154, v155
    v_permlane16_swap_b32 v224, v226
    v_permlane16_swap_b32 v225, v227
    v_pk_mul_f32 v[164:165], v[164:165], v[52:53]
    v_pk_mul_f32 v[166:167], v[166:167], v[52:53]
    v_pk_mul_f32 v[176:177], v[176:177], v[52:53]
    v_pk_mul_f32 v[178:179], v[178:179], v[52:53]
    v_cvt_pk_bf16_f32 v232, v164, v165
    v_cvt_pk_bf16_f32 v234, v176, v177
    v_cvt_pk_bf16_f32 v233, v166, v167
    v_cvt_pk_bf16_f32 v235, v178, v179
    v_permlane16_swap_b32 v228, v230
    v_permlane16_swap_b32 v229, v231
    v_pk_mul_f32 v[188:189], v[188:189], v[52:53]
    v_pk_mul_f32 v[190:191], v[190:191], v[52:53]
    v_pk_mul_f32 v[200:201], v[200:201], v[52:53]
    v_pk_mul_f32 v[202:203], v[202:203], v[52:53]
    v_cvt_pk_bf16_f32 v236, v188, v189
    v_cvt_pk_bf16_f32 v238, v200, v201
    v_cvt_pk_bf16_f32 v237, v190, v191
    v_cvt_pk_bf16_f32 v239, v202, v203
    v_permlane16_swap_b32 v232, v234
    v_permlane16_swap_b32 v233, v235
    s_nop 0
    v_permlane16_swap_b32 v236, v238
    v_permlane16_swap_b32 v237, v239
    v_rcp_f32 v52, v32
    s_nop 0
    v_mov_b32 v53, v52
    v_pk_mul_f32 v[120:121], v[120:121], v[52:53]
    v_pk_mul_f32 v[122:123], v[122:123], v[52:53]
    v_pk_mul_f32 v[132:133], v[132:133], v[52:53]
    v_pk_mul_f32 v[134:135], v[134:135], v[52:53]
    v_cvt_pk_bf16_f32 v240, v120, v121
    v_cvt_pk_bf16_f32 v242, v132, v133
    v_cvt_pk_bf16_f32 v241, v122, v123
    v_cvt_pk_bf16_f32 v243, v134, v135
    v_pk_mul_f32 v[144:145], v[144:145], v[52:53]
    v_pk_mul_f32 v[146:147], v[146:147], v[52:53]
    v_pk_mul_f32 v[156:157], v[156:157], v[52:53]
    v_pk_mul_f32 v[158:159], v[158:159], v[52:53]
    v_cvt_pk_bf16_f32 v244, v144, v145
    v_cvt_pk_bf16_f32 v246, v156, v157
    v_cvt_pk_bf16_f32 v245, v146, v147
    v_cvt_pk_bf16_f32 v247, v158, v159
    v_permlane16_swap_b32 v240, v242
    v_permlane16_swap_b32 v241, v243
    v_pk_mul_f32 v[168:169], v[168:169], v[52:53]
    v_pk_mul_f32 v[170:171], v[170:171], v[52:53]
    v_pk_mul_f32 v[180:181], v[180:181], v[52:53]
    v_pk_mul_f32 v[182:183], v[182:183], v[52:53]
    v_cvt_pk_bf16_f32 v248, v168, v169
    v_cvt_pk_bf16_f32 v250, v180, v181
    v_cvt_pk_bf16_f32 v249, v170, v171
    v_cvt_pk_bf16_f32 v251, v182, v183
    v_permlane16_swap_b32 v244, v246
    v_permlane16_swap_b32 v245, v247
    v_pk_mul_f32 v[192:193], v[192:193], v[52:53]
    v_pk_mul_f32 v[194:195], v[194:195], v[52:53]
    v_pk_mul_f32 v[204:205], v[204:205], v[52:53]
    v_pk_mul_f32 v[206:207], v[206:207], v[52:53]
    v_cvt_pk_bf16_f32 v252, v192, v193
    v_cvt_pk_bf16_f32 v254, v204, v205
    v_cvt_pk_bf16_f32 v253, v194, v195
    v_cvt_pk_bf16_f32 v255, v206, v207
    v_permlane16_swap_b32 v248, v250
    v_permlane16_swap_b32 v249, v251
    s_nop 0
    v_permlane16_swap_b32 v252, v254
    v_permlane16_swap_b32 v253, v255
    s_setpc_b64 s[24:25]
F_ASET:
    v_lshrrev_b32 v54, 4, v0
    s_lshr_b32 s60, s3, 1
    s_lshl_b32 s60, s60, 13
    v_bfe_u32 v52, v0, 3, 1
    v_lshrrev_b32 v53, 1, v54
    v_and_b32 v55, 1, v54
    v_lshl_or_b32 v1, v55, 1, v53
    v_xor_b32 v1, v1, v52
    v_lshlrev_b32 v1, 4, v1
    v_lshl_add_u32 v1, v52, 11, v1
    v_and_b32 v52, 7, v0
    v_lshl_add_u32 v1, v52, 6, v1
    v_add_u32 v1, s60, v1
    v_lshlrev_b32 v2, 11, v53
    v_bfe_u32 v52, v0, 2, 3
    v_lshl_add_u32 v2, v52, 6, v2
    v_lshl_add_u32 v2, v55, 5, v2
    v_and_b32 v52, 3, v0
    v_lshl_add_u32 v2, v52, 3, v2
    v_add_u32 v2, s60, v2
    v_xor_b32 v3, 32, v2
    s_mov_b32 s12, 0
    v_mov_b32 v8, 0x3f803f80
    v_mov_b32 v9, 0x3f803f80
    v_mov_b32 v10, 0x3f803f80
    v_mov_b32 v11, 0x3f803f80
    s_setpc_b64 s[24:25]
F_ATT:
    ds_read_b128 v[36:39], v1 offset:0
    ds_read_b128 v[40:43], v1 offset:512
    ds_read_b128 v[44:47], v1 offset:1024
    s_mov_b32 s63, 40960
    s_mov_b32 s62, 4294844416
    v_pk_mov_b32 v[24:25], 0, 0
    v_pk_mov_b32 v[26:27], 0, 0
    v_pk_mov_b32 v[28:29], 0, 0
    v_pk_mov_b32 v[30:31], 0, 0
    v_pk_mov_b32 v[32:33], 0, 0
    v_pk_mov_b32 v[34:35], 0, 0
    v_pk_mov_b32 v[112:113], 0, 0
    v_pk_mov_b32 v[114:115], 0, 0
    v_pk_mov_b32 v[116:117], 0, 0
    v_pk_mov_b32 v[118:119], 0, 0
    v_pk_mov_b32 v[120:121], 0, 0
    v_pk_mov_b32 v[122:123], 0, 0
    v_pk_mov_b32 v[124:125], 0, 0
    v_pk_mov_b32 v[126:127], 0, 0
    s_waitcnt lgkmcnt(2)
    v_mfma_f32_16x16x32_bf16 v[64:67], v[36:39], v[208:211], 0
    ds_read_b128 v[48:51], v1 offset:1536
    v_pk_mov_b32 v[128:129], 0, 0
    v_mfma_f32_16x16x32_bf16 v[72:75], v[36:39], v[224:227], 0
    v_pk_mov_b32 v[130:131], 0, 0
    v_pk_mov_b32 v[132:133], 0, 0
    v_mfma_f32_16x16x32_bf16 v[80:83], v[36:39], v[240:243], 0
    v_pk_mov_b32 v[134:135], 0, 0
    v_pk_mov_b32 v[136:137], 0, 0
    s_waitcnt lgkmcnt(2)
    v_mfma_f32_16x16x32_bf16 v[64:67], v[40:43], v[212:215], v[64:67]
    ds_read_b128 v[36:39], v1 offset:4096
    v_pk_mov_b32 v[138:139], 0, 0
    v_mfma_f32_16x16x32_bf16 v[72:75], v[40:43], v[228:231], v[72:75]
    v_pk_mov_b32 v[140:141], 0, 0
    v_pk_mov_b32 v[142:143], 0, 0
    v_mfma_f32_16x16x32_bf16 v[80:83], v[40:43], v[244:247], v[80:83]
    v_pk_mov_b32 v[144:145], 0, 0
    v_pk_mov_b32 v[146:147], 0, 0
    s_waitcnt lgkmcnt(2)
    v_mfma_f32_16x16x32_bf16 v[64:67], v[44:47], v[216:219], v[64:67]
    ds_read_b128 v[40:43], v1 offset:4608
    v_pk_mov_b32 v[148:149], 0, 0
    v_mfma_f32_16x16x32_bf16 v[72:75], v[44:47], v[232:235], v[72:75]
    v_pk_mov_b32 v[150:151], 0, 0
    v_pk_mov_b32 v[152:153], 0, 0
    v_mfma_f32_16x16x32_bf16 v[80:83], v[44:47], v[248:251], v[80:83]
    v_pk_mov_b32 v[154:155], 0, 0
    v_pk_mov_b32 v[156:157], 0, 0
    s_waitcnt lgkmcnt(2)
    v_mfma_f32_16x16x32_bf16 v[64:67], v[48:51], v[220:223], v[64:67]
    ds_read_b128 v[44:47], v1 offset:5120
    v_pk_mov_b32 v[158:159], 0, 0
    v_mfma_f32_16x16x32_bf16 v[72:75], v[48:51], v[236:239], v[72:75]
    v_pk_mov_b32 v[160:161], 0, 0
    v_pk_mov_b32 v[162:163], 0, 0
    v_mfma_f32_16x16x32_bf16 v[80:83], v[48:51], v[252:255], v[80:83]
    v_pk_mov_b32 v[164:165], 0, 0
    v_pk_mov_b32 v[166:167], 0, 0
    s_waitcnt lgkmcnt(2)
    v_mfma_f32_16x16x32_bf16 v[68:71], v[36:39], v[208:211], 0
    ds_read_b128 v[48:51], v1 offset:5632
    v_pk_mov_b32 v[168:169], 0, 0
    v_mfma_f32_16x16x32_bf16 v[76:79], v[36:39], v[224:227], 0
    v_pk_mov_b32 v[170:171], 0, 0
    v_pk_mov_b32 v[172:173], 0, 0
    v_mfma_f32_16x16x32_bf16 v[84:87], v[36:39], v[240:243], 0
    v_pk_mov_b32 v[174:175], 0, 0
    v_pk_mov_b32 v[176:177], 0, 0
    s_waitcnt lgkmcnt(2)
    v_mfma_f32_16x16x32_bf16 v[68:71], v[40:43], v[212:215], v[68:71]
    ds_read_b128 v[36:39], v1 offset:16384
    v_pk_mov_b32 v[178:179], 0, 0
    v_mfma_f32_16x16x32_bf16 v[76:79], v[40:43], v[228:231], v[76:79]
    v_pk_mov_b32 v[180:181], 0, 0
    v_pk_mov_b32 v[182:183], 0, 0
    v_mfma_f32_16x16x32_bf16 v[84:87], v[40:43], v[244:247], v[84:87]
    v_pk_mov_b32 v[184:185], 0, 0
    v_pk_mov_b32 v[186:187], 0, 0
    s_waitcnt lgkmcnt(2)
    v_mfma_f32_16x16x32_bf16 v[68:71], v[44:47], v[216:219], v[68:71]
    ds_read_b128 v[40:43], v1 offset:16896
    v_pk_mov_b32 v[188:189], 0, 0
    v_mfma_f32_16x16x32_bf16 v[76:79], v[44:47], v[232:235], v[76:79]
    v_pk_mov_b32 v[190:191], 0, 0
    v_pk_mov_b32 v[192:193], 0, 0
    v_mfma_f32_16x16x32_bf16 v[84:87], v[44:47], v[248:251], v[84:87]
    v_pk_mov_b32 v[194:195], 0, 0
    v_pk_mov_b32 v[196:197], 0, 0
    s_waitcnt lgkmcnt(2)
    v_mfma_f32_16x16x32_bf16 v[68:71], v[48:51], v[220:223], v[68:71]
    ds_read_b128 v[44:47], v1 offset:17408
    v_pk_mov_b32 v[198:199], 0, 0
    v_mfma_f32_16x16x32_bf16 v[76:79], v[48:51], v[236:239], v[76:79]
    v_pk_mov_b32 v[200:201], 0, 0
    v_pk_mov_b32 v[202:203], 0, 0
    v_mfma_f32_16x16x32_bf16 v[84:87], v[48:51], v[252:255], v[84:87]
    v_pk_mov_b32 v[204:205], 0, 0
    v_pk_mov_b32 v[206:207], 0, 0
    s_nop 5
    v_max3_f32 v52, v64, v65, v66
    v_max3_f32 v52, v52, v67, v68
    v_max3_f32 v52, v52, v69, v70
    v_max_f32 v52, v52, v71
    v_mov_b32 v56, v52
    s_nop 1
    v_permlane16_swap_b32 v52, v56
    v_max_f32 v52, v52, v56
    v_mov_b32 v56, v52
    s_nop 1
    v_permlane32_swap_b32 v52, v56
    v_max_f32 v52, v52, v56
    v_sub_f32 v64, v64, v52
    v_sub_f32 v65, v65, v52
    v_sub_f32 v66, v66, v52
    v_sub_f32 v67, v67, v52
    v_sub_f32 v68, v68, v52
    v_sub_f32 v69, v69, v52
    v_sub_f32 v70, v70, v52
    v_sub_f32 v71, v71, v52
    v_sub_f32 v12, 0, v52
    v_sub_f32 v13, 0, v52
    v_sub_f32 v14, 0, v52
    v_sub_f32 v15, 0, v52
    v_max3_f32 v53, v72, v73, v74
    v_max3_f32 v53, v53, v75, v76
    v_max3_f32 v53, v53, v77, v78
    v_max_f32 v53, v53, v79
    v_mov_b32 v56, v53
    s_nop 1
    v_permlane16_swap_b32 v53, v56
    v_max_f32 v53, v53, v56
    v_mov_b32 v56, v53
    s_nop 1
    v_permlane32_swap_b32 v53, v56
    v_max_f32 v53, v53, v56
    v_sub_f32 v72, v72, v53
    v_sub_f32 v73, v73, v53
    v_sub_f32 v74, v74, v53
    v_sub_f32 v75, v75, v53
    v_sub_f32 v76, v76, v53
    v_sub_f32 v77, v77, v53
    v_sub_f32 v78, v78, v53
    v_sub_f32 v79, v79, v53
    v_sub_f32 v16, 0, v53
    v_sub_f32 v17, 0, v53
    v_sub_f32 v18, 0, v53
    v_sub_f32 v19, 0, v53
    v_max3_f32 v54, v80, v81, v82
    v_max3_f32 v54, v54, v83, v84
    v_max3_f32 v54, v54, v85, v86
    v_max_f32 v54, v54, v87
    v_mov_b32 v56, v54
    s_nop 1
    v_permlane16_swap_b32 v54, v56
    v_max_f32 v54, v54, v56
    v_mov_b32 v56, v54
    s_nop 1
    v_permlane32_swap_b32 v54, v56
    v_max_f32 v54, v54, v56
    v_sub_f32 v80, v80, v54
    v_sub_f32 v81, v81, v54
    v_sub_f32 v82, v82, v54
    v_sub_f32 v83, v83, v54
    v_sub_f32 v84, v84, v54
    v_sub_f32 v85, v85, v54
    v_sub_f32 v86, v86, v54
    v_sub_f32 v87, v87, v54
    v_sub_f32 v20, 0, v54
    v_sub_f32 v21, 0, v54
    v_sub_f32 v22, 0, v54
    v_sub_f32 v23, 0, v54
    s_mov_b32 s13, 0
    s_add_u32 s12, s12, 1
    s_and_b32 s12, s12, 3
    s_cselect_b32 s16, s63, s62
L_al_38:
    s_waitcnt lgkmcnt(1)
    v_mfma_f32_16x16x32_bf16 v[88:91], v[36:39], v[208:211], v[12:15]
    ds_read_b128 v[48:51], v1 offset:17920
    v_exp_f32 v64, v64
    v_mfma_f32_16x16x32_bf16 v[88:91], v[40:43], v[212:215], v[88:91]
    v_exp_f32 v65, v65
    v_mfma_f32_16x16x32_bf16 v[96:99], v[40:43], v[228:231], v[16:19]
    v_exp_f32 v66, v66
    v_cvt_pk_bf16_f32 v64, v64, v65
    v_mfma_f32_16x16x32_bf16 v[96:99], v[36:39], v[224:227], v[96:99]
    v_exp_f32 v67, v67
    v_mfma_f32_16x16x32_bf16 v[104:107], v[36:39], v[240:243], v[20:23]
    v_exp_f32 v68, v68
    v_cvt_pk_bf16_f32 v65, v66, v67
    v_mfma_f32_16x16x32_bf16 v[104:107], v[40:43], v[244:247], v[104:107]
    v_exp_f32 v69, v69
    s_waitcnt lgkmcnt(0)
    v_mfma_f32_16x16x32_bf16 v[104:107], v[44:47], v[248:251], v[104:107]
    ds_read_b128 v[36:39], v1 offset:20480
    v_exp_f32 v70, v70
    v_cvt_pk_bf16_f32 v66, v68, v69
    v_mfma_f32_16x16x32_bf16 v[104:107], v[48:51], v[252:255], v[104:107]
    ds_read_b128 v[40:43], v1 offset:20992
    v_exp_f32 v71, v71
    v_mfma_f32_16x16x32_bf16 v[96:99], v[48:51], v[236:239], v[96:99]
    v_exp_f32 v72, v72
    v_cvt_pk_bf16_f32 v67, v70, v71
    v_mfma_f32_16x16x32_bf16 v[96:99], v[44:47], v[232:235], v[96:99]
    v_exp_f32 v73, v73
    v_mfma_f32_16x16x32_bf16 v[88:91], v[44:47], v[216:219], v[88:91]
    v_exp_f32 v74, v74
    v_cvt_pk_bf16_f32 v72, v72, v73
    v_mfma_f32_16x16x32_bf16 v[88:91], v[48:51], v[220:223], v[88:91]
    v_exp_f32 v75, v75
    s_waitcnt lgkmcnt(0)
    v_mfma_f32_16x16x32_bf16 v[92:95], v[36:39], v[208:211], v[12:15]
    ds_read_b128 v[44:47], v1 offset:21504
    v_exp_f32 v76, v76
    v_cvt_pk_bf16_f32 v73, v74, v75
    v_mfma_f32_16x16x32_bf16 v[92:95], v[40:43], v[212:215], v[92:95]
    ds_read_b128 v[48:51], v1 offset:22016
    v_exp_f32 v77, v77
    v_mfma_f32_16x16x32_bf16 v[100:103], v[40:43], v[228:231], v[16:19]
    v_exp_f32 v78, v78
    v_cvt_pk_bf16_f32 v74, v76, v77
    v_add_u32 v1, s16, v1
    v_mfma_f32_16x16x32_bf16 v[100:103], v[36:39], v[224:227], v[100:103]
    v_exp_f32 v79, v79
    v_add_u32 v2, s16, v2
    v_mfma_f32_16x16x32_bf16 v[108:111], v[36:39], v[240:243], v[20:23]
    v_exp_f32 v80, v80
    v_cvt_pk_bf16_f32 v75, v78, v79
    v_mfma_f32_16x16x32_bf16 v[108:111], v[40:43], v[244:247], v[108:111]
    v_exp_f32 v81, v81
    v_add_u32 v3, s16, v3
    s_waitcnt vmcnt(8) lgkmcnt(0)
    s_barrier
    v_mfma_f32_16x16x32_bf16 v[108:111], v[44:47], v[248:251], v[108:111]
    ds_read_b64_tr_b16 v[36:37], v2 offset:0
    v_exp_f32 v82, v82
    v_cvt_pk_bf16_f32 v80, v80, v81
    v_mfma_f32_16x16x32_bf16 v[108:111], v[48:51], v[252:255], v[108:111]
    ds_read_b64_tr_b16 v[38:39], v2 offset:4096
    v_exp_f32 v83, v83
    v_mfma_f32_16x16x32_bf16 v[100:103], v[48:51], v[236:239], v[100:103]
    ds_read_b64_tr_b16 v[40:41], v3 offset:0
    v_exp_f32 v84, v84
    v_cvt_pk_bf16_f32 v81, v82, v83
    v_mfma_f32_16x16x32_bf16 v[100:103], v[44:47], v[232:235], v[100:103]
    ds_read_b64_tr_b16 v[42:43], v3 offset:4096
    v_exp_f32 v85, v85
    v_mfma_f32_16x16x32_bf16 v[92:95], v[44:47], v[216:219], v[92:95]
    v_exp_f32 v86, v86
    v_cvt_pk_bf16_f32 v82, v84, v85
    v_mfma_f32_16x16x32_bf16 v[92:95], v[48:51], v[220:223], v[92:95]
    v_exp_f32 v87, v87
    v_mfma_f32_16x16x32_bf16 v[24:27], v[8:11], v[64:67], v[24:27]
    v_cvt_pk_bf16_f32 v83, v86, v87
    ds_read_b64_tr_b16 v[44:45], v2 offset:512
    v_mfma_f32_16x16x32_bf16 v[28:31], v[8:11], v[72:75], v[28:31]
    ds_read_b64_tr_b16 v[46:47], v2 offset:4608
    v_mfma_f32_16x16x32_bf16 v[32:35], v[8:11], v[80:83], v[32:35]
    s_waitcnt lgkmcnt(4)
    v_mfma_f32_16x16x32_bf16 v[120:123], v[36:39], v[80:83], v[120:123]
    ds_read_b64_tr_b16 v[48:49], v3 offset:512
    s_add_u32 s12, s12, 1
    v_mfma_f32_16x16x32_bf16 v[116:119], v[36:39], v[72:75], v[116:119]
    ds_read_b64_tr_b16 v[50:51], v3 offset:4608
    v_mfma_f32_16x16x32_bf16 v[112:115], v[36:39], v[64:67], v[112:115]
    s_and_b32 s12, s12, 3
    s_waitcnt lgkmcnt(4)
    v_mfma_f32_16x16x32_bf16 v[124:127], v[40:43], v[64:67], v[124:127]
    ds_read_b64_tr_b16 v[36:37], v2 offset:1024
    s_cselect_b32 s16, s63, s62
    v_mfma_f32_16x16x32_bf16 v[128:131], v[40:43], v[72:75], v[128:131]
    ds_read_b64_tr_b16 v[38:39], v2 offset:5120
    v_mfma_f32_16x16x32_bf16 v[132:135], v[40:43], v[80:83], v[132:135]
    v_max3_f32 v52, v88, v89, v90
    s_waitcnt lgkmcnt(4)
    v_mfma_f32_16x16x32_bf16 v[144:147], v[44:47], v[80:83], v[144:147]
    ds_read_b64_tr_b16 v[40:41], v3 offset:1024
    v_max3_f32 v53, v91, v96, v97
    v_mfma_f32_16x16x32_bf16 v[140:143], v[44:47], v[72:75], v[140:143]
    ds_read_b64_tr_b16 v[42:43], v3 offset:5120
    v_mfma_f32_16x16x32_bf16 v[136:139], v[44:47], v[64:67], v[136:139]
    v_max3_f32 v52, v52, v98, v99
    s_waitcnt lgkmcnt(4)
    v_mfma_f32_16x16x32_bf16 v[148:151], v[48:51], v[64:67], v[148:151]
    ds_read_b64_tr_b16 v[44:45], v2 offset:1536
    v_max3_f32 v53, v53, v104, v105
    v_mfma_f32_16x16x32_bf16 v[152:155], v[48:51], v[72:75], v[152:155]
    ds_read_b64_tr_b16 v[46:47], v2 offset:5632
    v_mfma_f32_16x16x32_bf16 v[156:159], v[48:51], v[80:83], v[156:159]
    v_max3_f32 v52, v52, v106, v107
    s_waitcnt lgkmcnt(4)
    v_mfma_f32_16x16x32_bf16 v[168:171], v[36:39], v[80:83], v[168:171]
    ds_read_b64_tr_b16 v[48:49], v3 offset:1536
    v_max3_f32 v53, v53, v92, v93
    v_mfma_f32_16x16x32_bf16 v[164:167], v[36:39], v[72:75], v[164:167]
    ds_read_b64_tr_b16 v[50:51], v3 offset:5632
    v_max3_f32 v52, v52, v94, v95
    v_mfma_f32_16x16x32_bf16 v[160:163], v[36:39], v[64:67], v[160:163]
    v_max3_f32 v53, v53, v100, v101
    s_waitcnt lgkmcnt(4)
    v_mfma_f32_16x16x32_bf16 v[172:175], v[40:43], v[64:67], v[172:175]
    ds_read_b128 v[36:39], v1 offset:16384
    v_max3_f32 v52, v52, v102, v103
    v_mfma_f32_16x16x32_bf16 v[176:179], v[40:43], v[72:75], v[176:179]
    v_max3_f32 v53, v53, v108, v109
    v_max3_f32 v52, v52, v110, v111
    v_mfma_f32_16x16x32_bf16 v[180:183], v[40:43], v[80:83], v[180:183]
    v_max_f32 v52, v52, v53
    s_waitcnt lgkmcnt(3)
    v_mfma_f32_16x16x32_bf16 v[192:195], v[44:47], v[80:83], v[192:195]
    ds_read_b128 v[40:43], v1 offset:16896
    v_cmp_lt_f32 vcc, 0x41000000, v52
    v_mfma_f32_16x16x32_bf16 v[188:191], v[44:47], v[72:75], v[188:191]
    s_cmp_eq_u32 s13, 7
    v_mfma_f32_16x16x32_bf16 v[184:187], v[44:47], v[64:67], v[184:187]
    s_waitcnt lgkmcnt(2)
    v_mfma_f32_16x16x32_bf16 v[196:199], v[48:51], v[64:67], v[196:199]
    ds_read_b128 v[44:47], v1 offset:17408
    v_mfma_f32_16x16x32_bf16 v[200:203], v[48:51], v[72:75], v[200:203]
    v_mfma_f32_16x16x32_bf16 v[204:207], v[48:51], v[80:83], v[204:207]
    s_cbranch_vccnz L_rare_40
L_back_41:
    s_cbranch_scc1 L_af_39
    s_waitcnt lgkmcnt(1)
    v_mfma_f32_16x16x32_bf16 v[64:67], v[36:39], v[208:211], v[12:15]
    ds_read_b128 v[48:51], v1 offset:17920
    v_exp_f32 v88, v88
    v_mfma_f32_16x16x32_bf16 v[64:67], v[40:43], v[212:215], v[64:67]
    v_exp_f32 v89, v89
    v_mfma_f32_16x16x32_bf16 v[72:75], v[40:43], v[228:231], v[16:19]
    v_exp_f32 v90, v90
    v_cvt_pk_bf16_f32 v88, v88, v89
    v_mfma_f32_16x16x32_bf16 v[72:75], v[36:39], v[224:227], v[72:75]
    v_exp_f32 v91, v91
    v_mfma_f32_16x16x32_bf16 v[80:83], v[36:39], v[240:243], v[20:23]
    v_exp_f32 v92, v92
    v_cvt_pk_bf16_f32 v89, v90, v91
    v_mfma_f32_16x16x32_bf16 v[80:83], v[40:43], v[244:247], v[80:83]
    v_exp_f32 v93, v93
    s_waitcnt lgkmcnt(0)
    v_mfma_f32_16x16x32_bf16 v[80:83], v[44:47], v[248:251], v[80:83]
    ds_read_b128 v[36:39], v1 offset:20480
    v_exp_f32 v94, v94
    v_cvt_pk_bf16_f32 v90, v92, v93
    v_mfma_f32_16x16x32_bf16 v[80:83], v[48:51], v[252:255], v[80:83]
    ds_read_b128 v[40:43], v1 offset:20992
    v_exp_f32 v95, v95
    v_mfma_f32_16x16x32_bf16 v[72:75], v[48:51], v[236:239], v[72:75]
    v_exp_f32 v96, v96
    v_cvt_pk_bf16_f32 v91, v94, v95
    v_mfma_f32_16x16x32_bf16 v[72:75], v[44:47], v[232:235], v[72:75]
    v_exp_f32 v97, v97
    v_mfma_f32_16x16x32_bf16 v[64:67], v[44:47], v[216:219], v[64:67]
    v_exp_f32 v98, v98
    v_cvt_pk_bf16_f32 v96, v96, v97
    v_mfma_f32_16x16x32_bf16 v[64:67], v[48:51], v[220:223], v[64:67]
    v_exp_f32 v99, v99
    s_waitcnt lgkmcnt(0)
    v_mfma_f32_16x16x32_bf16 v[68:71], v[36:39], v[208:211], v[12:15]
    ds_read_b128 v[44:47], v1 offset:21504
    v_exp_f32 v100, v100
    v_cvt_pk_bf16_f32 v97, v98, v99
    v_mfma_f32_16x16x32_bf16 v[68:71], v[40:43], v[212:215], v[68:71]
    ds_read_b128 v[48:51], v1 offset:22016
    v_exp_f32 v101, v101
    v_mfma_f32_16x16x32_bf16 v[76:79], v[40:43], v[228:231], v[16:19]
    v_exp_f32 v102, v102
    v_cvt_pk_bf16_f32 v98, v100, v101
    v_add_u32 v1, s16, v1
    v_mfma_f32_16x16x32_bf16 v[76:79], v[36:39], v[224:227], v[76:79]
    v_exp_f32 v103, v103
    v_add_u32 v2, s16, v2
    v_mfma_f32_16x16x32_bf16 v[84:87], v[36:39], v[240:243], v[20:23]
    v_exp_f32 v104, v104
    v_cvt_pk_bf16_f32 v99, v102, v103
    v_mfma_f32_16x16x32_bf16 v[84:87], v[40:43], v[244:247], v[84:87]
    v_exp_f32 v105, v105
    v_add_u32 v3, s16, v3
    s_waitcnt vmcnt(0) lgkmcnt(0)
    s_barrier
    v_mfma_f32_16x16x32_bf16 v[84:87], v[44:47], v[248:251], v[84:87]
    ds_read_b64_tr_b16 v[36:37], v2 offset:0
    v_exp_f32 v106, v106
    v_cvt_pk_bf16_f32 v104, v104, v105
    v_mfma_f32_16x16x32_bf16 v[84:87], v[48:51], v[252:255], v[84:87]
    ds_read_b64_tr_b16 v[38:39], v2 offset:4096
    v_exp_f32 v107, v107
    v_mfma_f32_16x16x32_bf16 v[76:79], v[48:51], v[236:239], v[76:79]
    ds_read_b64_tr_b16 v[40:41], v3 offset:0
    v_exp_f32 v108, v108
    v_cvt_pk_bf16_f32 v105, v106, v107
    v_mfma_f32_16x16x32_bf16 v[76:79], v[44:47], v[232:235], v[76:79]
    ds_read_b64_tr_b16 v[42:43], v3 offset:4096
    v_exp_f32 v109, v109
    v_mfma_f32_16x16x32_bf16 v[68:71], v[44:47], v[216:219], v[68:71]
    v_exp_f32 v110, v110
    v_cvt_pk_bf16_f32 v106, v108, v109
    v_mfma_f32_16x16x32_bf16 v[68:71], v[48:51], v[220:223], v[68:71]
    v_exp_f32 v111, v111
    v_mfma_f32_16x16x32_bf16 v[24:27], v[8:11], v[88:91], v[24:27]
    v_cvt_pk_bf16_f32 v107, v110, v111
    ds_read_b64_tr_b16 v[44:45], v2 offset:512
    v_mfma_f32_16x16x32_bf16 v[28:31], v[8:11], v[96:99], v[28:31]
    ds_read_b64_tr_b16 v[46:47], v2 offset:4608
    v_mfma_f32_16x16x32_bf16 v[32:35], v[8:11], v[104:107], v[32:35]
    s_waitcnt lgkmcnt(4)
    v_mfma_f32_16x16x32_bf16 v[120:123], v[36:39], v[104:107], v[120:123]
    ds_read_b64_tr_b16 v[48:49], v3 offset:512
    s_add_u32 s12, s12, 1
    v_mfma_f32_16x16x32_bf16 v[116:119], v[36:39], v[96:99], v[116:119]
    ds_read_b64_tr_b16 v[50:51], v3 offset:4608
    v_mfma_f32_16x16x32_bf16 v[112:115], v[36:39], v[88:91], v[112:115]
    s_and_b32 s12, s12, 3
    s_waitcnt lgkmcnt(4)
    v_mfma_f32_16x16x32_bf16 v[124:127], v[40:43], v[88:91], v[124:127]
    ds_read_b64_tr_b16 v[36:37], v2 offset:1024
    s_cselect_b32 s16, s63, s62
    v_mfma_f32_16x16x32_bf16 v[128:131], v[40:43], v[96:99], v[128:131]
    ds_read_b64_tr_b16 v[38:39], v2 offset:5120
    v_mfma_f32_16x16x32_bf16 v[132:135], v[40:43], v[104:107], v[132:135]
    v_max3_f32 v52, v64, v65, v66
    s_waitcnt lgkmcnt(4)
    v_mfma_f32_16x16x32_bf16 v[144:147], v[44:47], v[104:107], v[144:147]
    ds_read_b64_tr_b16 v[40:41], v3 offset:1024
    v_max3_f32 v53, v67, v72, v73
    v_mfma_f32_16x16x32_bf16 v[140:143], v[44:47], v[96:99], v[140:143]
    ds_read_b64_tr_b16 v[42:43], v3 offset:5120
    v_mfma_f32_16x16x32_bf16 v[136:139], v[44:47], v[88:91], v[136:139]
    v_max3_f32 v52, v52, v74, v75
    s_waitcnt lgkmcnt(4)
    v_mfma_f32_16x16x32_bf16 v[148:151], v[48:51], v[88:91], v[148:151]
    ds_read_b64_tr_b16 v[44:45], v2 offset:1536
    v_max3_f32 v53, v53, v80, v81
    v_mfma_f32_16x16x32_bf16 v[152:155], v[48:51], v[96:99], v[152:155]
    ds_read_b64_tr_b16 v[46:47], v2 offset:5632
    v_mfma_f32_16x16x32_bf16 v[156:159], v[48:51], v[104:107], v[156:159]
    v_max3_f32 v52, v52, v82, v83
    s_waitcnt lgkmcnt(4)
    v_mfma_f32_16x16x32_bf16 v[168:171], v[36:39], v[104:107], v[168:171]
    ds_read_b64_tr_b16 v[48:49], v3 offset:1536
    v_max3_f32 v53, v53, v68, v69
    v_mfma_f32_16x16x32_bf16 v[164:167], v[36:39], v[96:99], v[164:167]
    ds_read_b64_tr_b16 v[50:51], v3 offset:5632
    v_max3_f32 v52, v52, v70, v71
    v_mfma_f32_16x16x32_bf16 v[160:163], v[36:39], v[88:91], v[160:163]
    v_max3_f32 v53, v53, v76, v77
    s_waitcnt lgkmcnt(4)
    v_mfma_f32_16x16x32_bf16 v[172:175], v[40:43], v[88:91], v[172:175]
    ds_read_b128 v[36:39], v1 offset:16384
    v_max3_f32 v52, v52, v78, v79
    v_mfma_f32_16x16x32_bf16 v[176:179], v[40:43], v[96:99], v[176:179]
    v_max3_f32 v53, v53, v84, v85
    v_max3_f32 v52, v52, v86, v87
    v_mfma_f32_16x16x32_bf16 v[180:183], v[40:43], v[104:107], v[180:183]
    v_max_f32 v52, v52, v53
    s_waitcnt lgkmcnt(3)
    v_mfma_f32_16x16x32_bf16 v[192:195], v[44:47], v[104:107], v[192:195]
    ds_read_b128 v[40:43], v1 offset:16896
    v_cmp_lt_f32 vcc, 0x41000000, v52
    v_mfma_f32_16x16x32_bf16 v[188:191], v[44:47], v[96:99], v[188:191]
    s_add_u32 s13, s13, 1
    v_mfma_f32_16x16x32_bf16 v[184:187], v[44:47], v[88:91], v[184:187]
    s_waitcnt lgkmcnt(2)
    v_mfma_f32_16x16x32_bf16 v[196:199], v[48:51], v[88:91], v[196:199]
    ds_read_b128 v[44:47], v1 offset:17408
    v_mfma_f32_16x16x32_bf16 v[200:203], v[48:51], v[96:99], v[200:203]
    v_mfma_f32_16x16x32_bf16 v[204:207], v[48:51], v[104:107], v[204:207]
    s_cbranch_vccnz L_rare_42
L_back_43:
    s_branch L_al_38
L_rare_40:
    s_nop 7
    v_max3_f32 v52, v88, v89, v90
    v_max3_f32 v52, v52, v91, v92
    v_max3_f32 v52, v52, v93, v94
    v_max_f32 v52, v52, v95
    v_mov_b32 v56, v52
    s_nop 1
    v_permlane16_swap_b32 v52, v56
    v_max_f32 v52, v52, v56
    v_mov_b32 v56, v52
    s_nop 1
    v_permlane32_swap_b32 v52, v56
    v_max_f32 v52, v52, v56
    v_max_f32 v52, 0, v52
    v_sub_f32 v57, 0, v52
    v_exp_f32 v57, v57
    v_sub_f32 v88, v88, v52
    v_sub_f32 v89, v89, v52
    v_sub_f32 v90, v90, v52
    v_sub_f32 v91, v91, v52
    v_sub_f32 v92, v92, v52
    v_sub_f32 v93, v93, v52
    v_sub_f32 v94, v94, v52
    v_sub_f32 v95, v95, v52
    v_sub_f32 v12, v12, v52
    v_sub_f32 v13, v13, v52
    v_sub_f32 v14, v14, v52
    v_sub_f32 v15, v15, v52
    v_mul_f32 v24, v24, v57
    v_mul_f32 v25, v25, v57
    v_mul_f32 v26, v26, v57
    v_mul_f32 v27, v27, v57
    v_mul_f32 v112, v112, v57
    v_mul_f32 v113, v113, v57
    v_mul_f32 v114, v114, v57
    v_mul_f32 v115, v115, v57
    v_mul_f32 v124, v124, v57
    v_mul_f32 v125, v125, v57
    v_mul_f32 v126, v126, v57
    v_mul_f32 v127, v127, v57
    v_mul_f32 v136, v136, v57
    v_mul_f32 v137, v137, v57
    v_mul_f32 v138, v138, v57
    v_mul_f32 v139, v139, v57
    v_mul_f32 v148, v148, v57
    v_mul_f32 v149, v149, v57
    v_mul_f32 v150, v150, v57
    v_mul_f32 v151, v151, v57
    v_mul_f32 v160, v160, v57
    v_mul_f32 v161, v161, v57
    v_mul_f32 v162, v162, v57
    v_mul_f32 v163, v163, v57
    v_mul_f32 v172, v172, v57
    v_mul_f32 v173, v173, v57
    v_mul_f32 v174, v174, v57
    v_mul_f32 v175, v175, v57
    v_mul_f32 v184, v184, v57
    v_mul_f32 v185, v185, v57
    v_mul_f32 v186, v186, v57
    v_mul_f32 v187, v187, v57
    v_mul_f32 v196, v196, v57
    v_mul_f32 v197, v197, v57
    v_mul_f32 v198, v198, v57
    v_mul_f32 v199, v199, v57
    v_max3_f32 v53, v96, v97, v98
    v_max3_f32 v53, v53, v99, v100
    v_max3_f32 v53, v53, v101, v102
    v_max_f32 v53, v53, v103
    v_mov_b32 v56, v53
    s_nop 1
    v_permlane16_swap_b32 v53, v56
    v_max_f32 v53, v53, v56
    v_mov_b32 v56, v53
    s_nop 1
    v_permlane32_swap_b32 v53, v56
    v_max_f32 v53, v53, v56
    v_max_f32 v53, 0, v53
    v_sub_f32 v57, 0, v53
    v_exp_f32 v57, v57
    v_sub_f32 v96, v96, v53
    v_sub_f32 v97, v97, v53
    v_sub_f32 v98, v98, v53
    v_sub_f32 v99, v99, v53
    v_sub_f32 v100, v100, v53
    v_sub_f32 v101, v101, v53
    v_sub_f32 v102, v102, v53
    v_sub_f32 v103, v103, v53
    v_sub_f32 v16, v16, v53
    v_sub_f32 v17, v17, v53
    v_sub_f32 v18, v18, v53
    v_sub_f32 v19, v19, v53
    v_mul_f32 v28, v28, v57
    v_mul_f32 v29, v29, v57
    v_mul_f32 v30, v30, v57
    v_mul_f32 v31, v31, v57
    v_mul_f32 v116, v116, v57
    v_mul_f32 v117, v117, v57
    v_mul_f32 v118, v118, v57
    v_mul_f32 v119, v119, v57
    v_mul_f32 v128, v128, v57
    v_mul_f32 v129, v129, v57
    v_mul_f32 v130, v130, v57
    v_mul_f32 v131, v131, v57
    v_mul_f32 v140, v140, v57
    v_mul_f32 v141, v141, v57
    v_mul_f32 v142, v142, v57
    v_mul_f32 v143, v143, v57
    v_mul_f32 v152, v152, v57
    v_mul_f32 v153, v153, v57
    v_mul_f32 v154, v154, v57
    v_mul_f32 v155, v155, v57
    v_mul_f32 v164, v164, v57
    v_mul_f32 v165, v165, v57
    v_mul_f32 v166, v166, v57
    v_mul_f32 v167, v167, v57
    v_mul_f32 v176, v176, v57
    v_mul_f32 v177, v177, v57
    v_mul_f32 v178, v178, v57
    v_mul_f32 v179, v179, v57
    v_mul_f32 v188, v188, v57
    v_mul_f32 v189, v189, v57
    v_mul_f32 v190, v190, v57
    v_mul_f32 v191, v191, v57
    v_mul_f32 v200, v200, v57
    v_mul_f32 v201, v201, v57
    v_mul_f32 v202, v202, v57
    v_mul_f32 v203, v203, v57
    v_max3_f32 v54, v104, v105, v106
    v_max3_f32 v54, v54, v107, v108
    v_max3_f32 v54, v54, v109, v110
    v_max_f32 v54, v54, v111
    v_mov_b32 v56, v54
    s_nop 1
    v_permlane16_swap_b32 v54, v56
    v_max_f32 v54, v54, v56
    v_mov_b32 v56, v54
    s_nop 1
    v_permlane32_swap_b32 v54, v56
    v_max_f32 v54, v54, v56
    v_max_f32 v54, 0, v54
    v_sub_f32 v57, 0, v54
    v_exp_f32 v57, v57
    v_sub_f32 v104, v104, v54
    v_sub_f32 v105, v105, v54
    v_sub_f32 v106, v106, v54
    v_sub_f32 v107, v107, v54
    v_sub_f32 v108, v108, v54
    v_sub_f32 v109, v109, v54
    v_sub_f32 v110, v110, v54
    v_sub_f32 v111, v111, v54
    v_sub_f32 v20, v20, v54
    v_sub_f32 v21, v21, v54
    v_sub_f32 v22, v22, v54
    v_sub_f32 v23, v23, v54
    v_mul_f32 v32, v32, v57
    v_mul_f32 v33, v33, v57
    v_mul_f32 v34, v34, v57
    v_mul_f32 v35, v35, v57
    v_mul_f32 v120, v120, v57
    v_mul_f32 v121, v121, v57
    v_mul_f32 v122, v122, v57
    v_mul_f32 v123, v123, v57
    v_mul_f32 v132, v132, v57
    v_mul_f32 v133, v133, v57
    v_mul_f32 v134, v134, v57
    v_mul_f32 v135, v135, v57
    v_mul_f32 v144, v144, v57
    v_mul_f32 v145, v145, v57
    v_mul_f32 v146, v146, v57
    v_mul_f32 v147, v147, v57
    v_mul_f32 v156, v156, v57
    v_mul_f32 v157, v157, v57
    v_mul_f32 v158, v158, v57
    v_mul_f32 v159, v159, v57
    v_mul_f32 v168, v168, v57
    v_mul_f32 v169, v169, v57
    v_mul_f32 v170, v170, v57
    v_mul_f32 v171, v171, v57
    v_mul_f32 v180, v180, v57
    v_mul_f32 v181, v181, v57
    v_mul_f32 v182, v182, v57
    v_mul_f32 v183, v183, v57
    v_mul_f32 v192, v192, v57
    v_mul_f32 v193, v193, v57
    v_mul_f32 v194, v194, v57
    v_mul_f32 v195, v195, v57
    v_mul_f32 v204, v204, v57
    v_mul_f32 v205, v205, v57
    v_mul_f32 v206, v206, v57
    v_mul_f32 v207, v207, v57
    s_nop 1
    s_branch L_back_41
L_rare_42:
    s_nop 7
    v_max3_f32 v52, v64, v65, v66
    v_max3_f32 v52, v52, v67, v68
    v_max3_f32 v52, v52, v69, v70
    v_max_f32 v52, v52, v71
    v_mov_b32 v56, v52
    s_nop 1
    v_permlane16_swap_b32 v52, v56
    v_max_f32 v52, v52, v56
    v_mov_b32 v56, v52
    s_nop 1
    v_permlane32_swap_b32 v52, v56
    v_max_f32 v52, v52, v56
    v_max_f32 v52, 0, v52
    v_sub_f32 v57, 0, v52
    v_exp_f32 v57, v57
    v_sub_f32 v64, v64, v52
    v_sub_f32 v65, v65, v52
    v_sub_f32 v66, v66, v52
    v_sub_f32 v67, v67, v52
    v_sub_f32 v68, v68, v52
    v_sub_f32 v69, v69, v52
    v_sub_f32 v70, v70, v52
    v_sub_f32 v71, v71, v52
    v_sub_f32 v12, v12, v52
    v_sub_f32 v13, v13, v52
    v_sub_f32 v14, v14, v52
    v_sub_f32 v15, v15, v52
    v_mul_f32 v24, v24, v57
    v_mul_f32 v25, v25, v57
    v_mul_f32 v26, v26, v57
    v_mul_f32 v27, v27, v57
    v_mul_f32 v112, v112, v57
    v_mul_f32 v113, v113, v57
    v_mul_f32 v114, v114, v57
    v_mul_f32 v115, v115, v57
    v_mul_f32 v124, v124, v57
    v_mul_f32 v125, v125, v57
    v_mul_f32 v126, v126, v57
    v_mul_f32 v127, v127, v57
    v_mul_f32 v136, v136, v57
    v_mul_f32 v137, v137, v57
    v_mul_f32 v138, v138, v57
    v_mul_f32 v139, v139, v57
    v_mul_f32 v148, v148, v57
    v_mul_f32 v149, v149, v57
    v_mul_f32 v150, v150, v57
    v_mul_f32 v151, v151, v57
    v_mul_f32 v160, v160, v57
    v_mul_f32 v161, v161, v57
    v_mul_f32 v162, v162, v57
    v_mul_f32 v163, v163, v57
    v_mul_f32 v172, v172, v57
    v_mul_f32 v173, v173, v57
    v_mul_f32 v174, v174, v57
    v_mul_f32 v175, v175, v57
    v_mul_f32 v184, v184, v57
    v_mul_f32 v185, v185, v57
    v_mul_f32 v186, v186, v57
    v_mul_f32 v187, v187, v57
    v_mul_f32 v196, v196, v57
    v_mul_f32 v197, v197, v57
    v_mul_f32 v198, v198, v57
    v_mul_f32 v199, v199, v57
    v_max3_f32 v53, v72, v73, v74
    v_max3_f32 v53, v53, v75, v76
    v_max3_f32 v53, v53, v77, v78
    v_max_f32 v53, v53, v79
    v_mov_b32 v56, v53
    s_nop 1
    v_permlane16_swap_b32 v53, v56
    v_max_f32 v53, v53, v56
    v_mov_b32 v56, v53
    s_nop 1
    v_permlane32_swap_b32 v53, v56
    v_max_f32 v53, v53, v56
    v_max_f32 v53, 0, v53
    v_sub_f32 v57, 0, v53
    v_exp_f32 v57, v57
    v_sub_f32 v72, v72, v53
    v_sub_f32 v73, v73, v53
    v_sub_f32 v74, v74, v53
    v_sub_f32 v75, v75, v53
    v_sub_f32 v76, v76, v53
    v_sub_f32 v77, v77, v53
    v_sub_f32 v78, v78, v53
    v_sub_f32 v79, v79, v53
    v_sub_f32 v16, v16, v53
    v_sub_f32 v17, v17, v53
    v_sub_f32 v18, v18, v53
    v_sub_f32 v19, v19, v53
    v_mul_f32 v28, v28, v57
    v_mul_f32 v29, v29, v57
    v_mul_f32 v30, v30, v57
    v_mul_f32 v31, v31, v57
    v_mul_f32 v116, v116, v57
    v_mul_f32 v117, v117, v57
    v_mul_f32 v118, v118, v57
    v_mul_f32 v119, v119, v57
    v_mul_f32 v128, v128, v57
    v_mul_f32 v129, v129, v57
    v_mul_f32 v130, v130, v57
    v_mul_f32 v131, v131, v57
    v_mul_f32 v140, v140, v57
    v_mul_f32 v141, v141, v57
    v_mul_f32 v142, v142, v57
    v_mul_f32 v143, v143, v57
    v_mul_f32 v152, v152, v57
    v_mul_f32 v153, v153, v57
    v_mul_f32 v154, v154, v57
    v_mul_f32 v155, v155, v57
    v_mul_f32 v164, v164, v57
    v_mul_f32 v165, v165, v57
    v_mul_f32 v166, v166, v57
    v_mul_f32 v167, v167, v57
    v_mul_f32 v176, v176, v57
    v_mul_f32 v177, v177, v57
    v_mul_f32 v178, v178, v57
    v_mul_f32 v179, v179, v57
    v_mul_f32 v188, v188, v57
    v_mul_f32 v189, v189, v57
    v_mul_f32 v190, v190, v57
    v_mul_f32 v191, v191, v57
    v_mul_f32 v200, v200, v57
    v_mul_f32 v201, v201, v57
    v_mul_f32 v202, v202, v57
    v_mul_f32 v203, v203, v57
    v_max3_f32 v54, v80, v81, v82
    v_max3_f32 v54, v54, v83, v84
    v_max3_f32 v54, v54, v85, v86
    v_max_f32 v54, v54, v87
    v_mov_b32 v56, v54
    s_nop 1
    v_permlane16_swap_b32 v54, v56
    v_max_f32 v54, v54, v56
    v_mov_b32 v56, v54
    s_nop 1
    v_permlane32_swap_b32 v54, v56
    v_max_f32 v54, v54, v56
    v_max_f32 v54, 0, v54
    v_sub_f32 v57, 0, v54
    v_exp_f32 v57, v57
    v_sub_f32 v80, v80, v54
    v_sub_f32 v81, v81, v54
    v_sub_f32 v82, v82, v54
    v_sub_f32 v83, v83, v54
    v_sub_f32 v84, v84, v54
    v_sub_f32 v85, v85, v54
    v_sub_f32 v86, v86, v54
    v_sub_f32 v87, v87, v54
    v_sub_f32 v20, v20, v54
    v_sub_f32 v21, v21, v54
    v_sub_f32 v22, v22, v54
    v_sub_f32 v23, v23, v54
    v_mul_f32 v32, v32, v57
    v_mul_f32 v33, v33, v57
    v_mul_f32 v34, v34, v57
    v_mul_f32 v35, v35, v57
    v_mul_f32 v120, v120, v57
    v_mul_f32 v121, v121, v57
    v_mul_f32 v122, v122, v57
    v_mul_f32 v123, v123, v57
    v_mul_f32 v132, v132, v57
    v_mul_f32 v133, v133, v57
    v_mul_f32 v134, v134, v57
    v_mul_f32 v135, v135, v57
    v_mul_f32 v144, v144, v57
    v_mul_f32 v145, v145, v57
    v_mul_f32 v146, v146, v57
    v_mul_f32 v147, v147, v57
    v_mul_f32 v156, v156, v57
    v_mul_f32 v157, v157, v57
    v_mul_f32 v158, v158, v57
    v_mul_f32 v159, v159, v57
    v_mul_f32 v168, v168, v57
    v_mul_f32 v169, v169, v57
    v_mul_f32 v170, v170, v57
    v_mul_f32 v171, v171, v57
    v_mul_f32 v180, v180, v57
    v_mul_f32 v181, v181, v57
    v_mul_f32 v182, v182, v57
    v_mul_f32 v183, v183, v57
    v_mul_f32 v192, v192, v57
    v_mul_f32 v193, v193, v57
    v_mul_f32 v194, v194, v57
    v_mul_f32 v195, v195, v57
    v_mul_f32 v204, v204, v57
    v_mul_f32 v205, v205, v57
    v_mul_f32 v206, v206, v57
    v_mul_f32 v207, v207, v57
    s_nop 1
    s_branch L_back_43
L_af_39:
    ds_read_b64_tr_b16 v[36:37], v2 offset:16384
    ds_read_b64_tr_b16 v[38:39], v2 offset:20480
    ds_read_b64_tr_b16 v[40:41], v3 offset:16384
    ds_read_b64_tr_b16 v[42:43], v3 offset:20480
    ds_read_b64_tr_b16 v[44:45], v2 offset:16896
    ds_read_b64_tr_b16 v[46:47], v2 offset:20992
    v_exp_f32 v88, v88
    v_exp_f32 v89, v89
    v_exp_f32 v90, v90
    v_cvt_pk_bf16_f32 v88, v88, v89
    v_exp_f32 v91, v91
    v_exp_f32 v92, v92
    v_cvt_pk_bf16_f32 v89, v90, v91
    v_exp_f32 v93, v93
    v_exp_f32 v94, v94
    v_cvt_pk_bf16_f32 v90, v92, v93
    v_exp_f32 v95, v95
    v_exp_f32 v96, v96
    v_cvt_pk_bf16_f32 v91, v94, v95
    v_exp_f32 v97, v97
    v_exp_f32 v98, v98
    v_cvt_pk_bf16_f32 v96, v96, v97
    v_exp_f32 v99, v99
    v_exp_f32 v100, v100
    v_cvt_pk_bf16_f32 v97, v98, v99
    v_exp_f32 v101, v101
    v_exp_f32 v102, v102
    v_cvt_pk_bf16_f32 v98, v100, v101
    v_exp_f32 v103, v103
    v_exp_f32 v104, v104
    v_cvt_pk_bf16_f32 v99, v102, v103
    v_exp_f32 v105, v105
    v_exp_f32 v106, v106
    v_cvt_pk_bf16_f32 v104, v104, v105
    v_exp_f32 v107, v107
    v_exp_f32 v108, v108
    v_cvt_pk_bf16_f32 v105, v106, v107
    v_exp_f32 v109, v109
    v_exp_f32 v110, v110
    v_cvt_pk_bf16_f32 v106, v108, v109
    v_exp_f32 v111, v111
    v_mfma_f32_16x16x32_bf16 v[24:27], v[8:11], v[88:91], v[24:27]
    v_cvt_pk_bf16_f32 v107, v110, v111
    v_mfma_f32_16x16x32_bf16 v[28:31], v[8:11], v[96:99], v[28:31]
    s_nop 0
    v_mfma_f32_16x16x32_bf16 v[32:35], v[8:11], v[104:107], v[32:35]
    s_waitcnt lgkmcnt(4)
    v_mfma_f32_16x16x32_bf16 v[120:123], v[36:39], v[104:107], v[120:123]
    ds_read_b64_tr_b16 v[48:49], v3 offset:16896
    v_mfma_f32_16x16x32_bf16 v[116:119], v[36:39], v[96:99], v[116:119]
    ds_read_b64_tr_b16 v[50:51], v3 offset:20992
    v_mfma_f32_16x16x32_bf16 v[112:115], v[36:39], v[88:91], v[112:115]
    s_waitcnt lgkmcnt(4)
    v_mfma_f32_16x16x32_bf16 v[124:127], v[40:43], v[88:91], v[124:127]
    ds_read_b64_tr_b16 v[36:37], v2 offset:17408
    v_mfma_f32_16x16x32_bf16 v[128:131], v[40:43], v[96:99], v[128:131]
    ds_read_b64_tr_b16 v[38:39], v2 offset:21504
    v_mfma_f32_16x16x32_bf16 v[132:135], v[40:43], v[104:107], v[132:135]
    s_waitcnt lgkmcnt(4)
    v_mfma_f32_16x16x32_bf16 v[144:147], v[44:47], v[104:107], v[144:147]
    ds_read_b64_tr_b16 v[40:41], v3 offset:17408
    v_mfma_f32_16x16x32_bf16 v[140:143], v[44:47], v[96:99], v[140:143]
    ds_read_b64_tr_b16 v[42:43], v3 offset:21504
    v_mfma_f32_16x16x32_bf16 v[136:139], v[44:47], v[88:91], v[136:139]
    s_waitcnt lgkmcnt(4)
    v_mfma_f32_16x16x32_bf16 v[148:151], v[48:51], v[88:91], v[148:151]
    ds_read_b64_tr_b16 v[44:45], v2 offset:17920
    v_mfma_f32_16x16x32_bf16 v[152:155], v[48:51], v[96:99], v[152:155]
    ds_read_b64_tr_b16 v[46:47], v2 offset:22016
    v_mfma_f32_16x16x32_bf16 v[156:159], v[48:51], v[104:107], v[156:159]
    s_waitcnt lgkmcnt(4)
    v_mfma_f32_16x16x32_bf16 v[168:171], v[36:39], v[104:107], v[168:171]
    ds_read_b64_tr_b16 v[48:49], v3 offset:17920
    v_mfma_f32_16x16x32_bf16 v[164:167], v[36:39], v[96:99], v[164:167]
    ds_read_b64_tr_b16 v[50:51], v3 offset:22016
    v_mfma_f32_16x16x32_bf16 v[160:163], v[36:39], v[88:91], v[160:163]
    s_waitcnt lgkmcnt(4)
    v_mfma_f32_16x16x32_bf16 v[172:175], v[40:43], v[88:91], v[172:175]
    v_mfma_f32_16x16x32_bf16 v[176:179], v[40:43], v[96:99], v[176:179]
    v_mfma_f32_16x16x32_bf16 v[180:183], v[40:43], v[104:107], v[180:183]
    s_waitcnt lgkmcnt(2)
    v_mfma_f32_16x16x32_bf16 v[192:195], v[44:47], v[104:107], v[192:195]
    v_mfma_f32_16x16x32_bf16 v[188:191], v[44:47], v[96:99], v[188:191]
    v_mfma_f32_16x16x32_bf16 v[184:187], v[44:47], v[88:91], v[184:187]
    s_waitcnt lgkmcnt(0)
    v_mfma_f32_16x16x32_bf16 v[196:199], v[48:51], v[88:91], v[196:199]
    v_mfma_f32_16x16x32_bf16 v[200:203], v[48:51], v[96:99], v[200:203]
    v_mfma_f32_16x16x32_bf16 v[204:207], v[48:51], v[104:107], v[204:207]
    s_nop 6
    s_setpc_b64 s[26:27]
F_TAIL:
    ds_read_b64_tr_b16 v[88:89], v2 offset:0
    ds_read_b64_tr_b16 v[90:91], v2 offset:256
    ds_read_b64_tr_b16 v[92:93], v2 offset:4096
    ds_read_b64_tr_b16 v[94:95], v2 offset:4352
    ds_read_b64_tr_b16 v[96:97], v3 offset:0
    ds_read_b128 v[64:67], v1 offset:0
    ds_read_b128 v[76:79], v1 offset:512
    ds_read_b64_tr_b16 v[98:99], v3 offset:256
    ds_read_b128 v[68:71], v1 offset:2048
    ds_read_b128 v[80:83], v1 offset:2560
    ds_read_b64_tr_b16 v[100:101], v3 offset:4096
    ds_read_b128 v[72:75], v1 offset:4096
    ds_read_b128 v[84:87], v1 offset:4608
    ds_read_b64_tr_b16 v[102:103], v3 offset:4352
    s_mov_b32 s63, 40960
    s_mov_b32 s62, 4294844416
    s_mov_b32 s13, 0
    s_branch F_TAIL_P1
L_gl_44:
    s_barrier
L_gb_45:
    v_mfma_f32_16x16x32_bf16 v[140:143], v[108:111], v[80:83], v[140:143]
    ds_read_b64_tr_b16 v[88:89], v2 offset:0
    v_mfma_f32_16x16x32_bf16 v[140:143], v[104:107], v[68:71], v[140:143]
    ds_read_b64_tr_b16 v[90:91], v2 offset:256
    v_mfma_f32_16x16x32_bf16 v[144:147], v[104:107], v[72:75], v[144:147]
    ds_read_b64_tr_b16 v[92:93], v2 offset:4096
    v_mfma_f32_16x16x32_bf16 v[144:147], v[108:111], v[84:87], v[144:147]
    ds_read_b64_tr_b16 v[94:95], v2 offset:4352
    v_mfma_f32_16x16x32_bf16 v[148:151], v[40:43], v[76:79], v[148:151]
    ds_read_b64_tr_b16 v[96:97], v3 offset:0
    v_mfma_f32_16x16x32_bf16 v[148:151], v[36:39], v[64:67], v[148:151]
    ds_read_b128 v[64:67], v1 offset:0
    ds_read_b128 v[76:79], v1 offset:512
    v_mfma_f32_16x16x32_bf16 v[152:155], v[36:39], v[68:71], v[152:155]
    ds_read_b64_tr_b16 v[98:99], v3 offset:256
    v_mfma_f32_16x16x32_bf16 v[152:155], v[40:43], v[80:83], v[152:155]
    ds_read_b128 v[68:71], v1 offset:2048
    ds_read_b128 v[80:83], v1 offset:2560
    v_mfma_f32_16x16x32_bf16 v[156:159], v[40:43], v[84:87], v[156:159]
    ds_read_b64_tr_b16 v[100:101], v3 offset:4096
    v_mfma_f32_16x16x32_bf16 v[156:159], v[36:39], v[72:75], v[156:159]
    ds_read_b128 v[72:75], v1 offset:4096
    ds_read_b128 v[84:87], v1 offset:4608
    ds_read_b64_tr_b16 v[102:103], v3 offset:4352
F_TAIL_P1:
    s_waitcnt lgkmcnt(7)
    v_mfma_f32_16x16x32_bf16 v[112:115], v[88:91], v[64:67], v[112:115]
    ds_read_b64_tr_b16 v[104:105], v2 offset:512
    v_mfma_f32_16x16x32_bf16 v[112:115], v[92:95], v[76:79], v[112:115]
    ds_read_b64_tr_b16 v[106:107], v2 offset:768
    s_waitcnt lgkmcnt(6)
    v_mfma_f32_16x16x32_bf16 v[116:119], v[92:95], v[80:83], v[116:119]
    ds_read_b64_tr_b16 v[108:109], v2 offset:4608
    v_mfma_f32_16x16x32_bf16 v[116:119], v[88:91], v[68:71], v[116:119]
    ds_read_b64_tr_b16 v[110:111], v2 offset:4864
    s_waitcnt lgkmcnt(5)
    v_mfma_f32_16x16x32_bf16 v[120:123], v[88:91], v[72:75], v[120:123]
    s_add_u32 s12, s12, 1
    s_and_b32 s12, s12, 3
    v_mfma_f32_16x16x32_bf16 v[120:123], v[92:95], v[84:87], v[120:123]
    s_cselect_b32 s16, s63, s62
    s_add_u32 s13, s13, 1
    s_waitcnt lgkmcnt(4)
    v_mfma_f32_16x16x32_bf16 v[132:135], v[100:103], v[84:87], v[132:135]
    ds_read_b64_tr_b16 v[36:37], v3 offset:512
    ds_read_b64_tr_b16 v[38:39], v3 offset:768
    v_mfma_f32_16x16x32_bf16 v[132:135], v[96:99], v[72:75], v[132:135]
    ds_read_b64_tr_b16 v[40:41], v3 offset:4608
    ds_read_b64_tr_b16 v[42:43], v3 offset:4864
    v_mfma_f32_16x16x32_bf16 v[128:131], v[96:99], v[68:71], v[128:131]
    v_add_u32 v1, s16, v1
    v_mfma_f32_16x16x32_bf16 v[128:131], v[100:103], v[80:83], v[128:131]
    v_add_u32 v2, s16, v2
    v_mfma_f32_16x16x32_bf16 v[124:127], v[100:103], v[76:79], v[124:127]
    v_add_u32 v3, s16, v3
    v_mfma_f32_16x16x32_bf16 v[124:127], v[96:99], v[64:67], v[124:127]
    s_waitcnt lgkmcnt(4)
    v_mfma_f32_16x16x32_bf16 v[136:139], v[104:107], v[64:67], v[136:139]
    s_cmp_lg_u32 s13, s15
    v_mfma_f32_16x16x32_bf16 v[136:139], v[108:111], v[76:79], v[136:139]
    s_waitcnt lgkmcnt(0)
    s_cbranch_scc1 L_gl_44
L_gs_46:
    s_cmp_eq_u32 s13, s14
    s_cbranch_scc1 L_gf_47
    s_cmp_eq_u32 s17, 0
    s_cbranch_scc1 L_hk_48
    s_waitcnt vmcnt(0)
    s_barrier
    s_call_b64 s[24:25], F_SIG
    s_mov_b32 s17, 0
    s_branch L_hk2end
L_hk_48:
    s_barrier
    s_xor_b32 s60, s2, 2
    s_mul_i32 s60, s60, 49152
    s_mul_i32 s61, s3, 12288
    s_add_u32 s60, s60, s61
    s_add_u32 s60, s60, 67108864
    v_lshlrev_b32 v4, 4, v0
    buffer_load_dwordx4 v[232:235], v4, s[48:51], s60 offen offset:0 sc1
    buffer_load_dwordx4 v[236:239], v4, s[48:51], s60 offen offset:1024 sc1
    buffer_load_dwordx4 v[240:243], v4, s[48:51], s60 offen offset:2048 sc1
    buffer_load_dwordx4 v[244:247], v4, s[48:51], s60 offen offset:3072 sc1
    s_add_u32 s60, s60, 4096
    buffer_load_dwordx4 v[248:251], v4, s[48:51], s60 offen offset:0 sc1
    buffer_load_dwordx4 v[252:255], v4, s[48:51], s60 offen offset:1024 sc1
L_hk2end:
    s_mov_b32 s15, s1
    s_mov_b32 s1, s14
    s_branch L_gb_45
L_gf_47:
    v_mfma_f32_16x16x32_bf16 v[140:143], v[108:111], v[80:83], v[140:143]
    v_mfma_f32_16x16x32_bf16 v[140:143], v[104:107], v[68:71], v[140:143]
    v_mfma_f32_16x16x32_bf16 v[144:147], v[104:107], v[72:75], v[144:147]
    v_mfma_f32_16x16x32_bf16 v[144:147], v[108:111], v[84:87], v[144:147]
    v_mfma_f32_16x16x32_bf16 v[148:151], v[40:43], v[76:79], v[148:151]
    v_mfma_f32_16x16x32_bf16 v[148:151], v[36:39], v[64:67], v[148:151]
    v_mfma_f32_16x16x32_bf16 v[152:155], v[36:39], v[68:71], v[152:155]
    v_mfma_f32_16x16x32_bf16 v[152:155], v[40:43], v[80:83], v[152:155]
    v_mfma_f32_16x16x32_bf16 v[156:159], v[40:43], v[84:87], v[156:159]
    v_mfma_f32_16x16x32_bf16 v[156:159], v[36:39], v[72:75], v[156:159]
    s_nop 6
    s_setpc_b64 s[26:27]
L_finish:
L_end:
    s_endpgm
.section .rodata,"a"
.p2align 6
.amdhsa_kernel concat_heads__mha_block_cached__gqa_block_cached__near_ridge_kernel
  .amdhsa_next_free_vgpr 256
  .amdhsa_next_free_sgpr 102
  .amdhsa_accum_offset 256
  .amdhsa_group_segment_fixed_size 0
  .amdhsa_kernarg_size 104
  .amdhsa_user_sgpr_count 2
  .amdhsa_user_sgpr_kernarg_segment_ptr 1
  .amdhsa_system_sgpr_workgroup_id_x 1
.end_amdhsa_kernel
```
